```python
import torch

def _softmax(x, axis=-1):
    return torch.softmax(x, dim=axis)
def _gelu(x):
    return torch.nn.functional.gelu(x, approximate="tanh")
def _silu(x):
    return torch.nn.functional.silu(x)
def _sigmoid(x):
    return torch.sigmoid(x)
def _layernorm(x, axis=-1, eps=1e-5):
    m = x.mean(dim=axis, keepdim=True)
    v = x.var(dim=axis, keepdim=True, unbiased=False)
    return (x - m) / torch.sqrt(v + eps)
def _scatter_add(tgt, idx, src, axis=0):
    return tgt.clone().index_add_(axis, idx, src)
def _segment_sum(src, seg, n):
    out = torch.zeros((n,) + src.shape[1:], dtype=src.dtype)
    return out.index_add_(0, seg, src)
def _pad(x, pw):
    flat = tuple(v for pair in reversed(pw) for v in pair)
    return torch.nn.functional.pad(x, flat)

kernel_name = 'recurrent_scan__mha_block__glu_gated_reglu__prompt'

def setup_inputs():

    _w = (lambda a: (lambda t: t.to(torch.bfloat16) if t.is_floating_point() else t)(torch.as_tensor(a)))
    def _A_setup():
        B, S, D, H = 1, 2048, 512, 32
        return {
            "x": _w((lambda *s: torch.randn(*s, dtype=torch.bfloat16) * 0.05)(B, S, D)),
            "wqkv": _w((lambda *s: torch.randn(*s, dtype=torch.bfloat16) * 0.2)(D, 3 * D)),
            "wo": _w((lambda *s: torch.randn(*s, dtype=torch.bfloat16) * 0.2)(D, D)),
        }
    _A_in = _A_setup()

    def _B_setup():
        B, S, D, F = 1, 2048, 512, 1792
        return {
            "x": _w((lambda *s: torch.randn(*s, dtype=torch.bfloat16) * 0.05)(B, S, D)),
            "W_gate": _w((lambda *s: torch.randn(*s, dtype=torch.bfloat16) * 0.1)(D, F) * (2.0 / D) ** 0.5),
            "W_up": _w((lambda *s: torch.randn(*s, dtype=torch.bfloat16) * 0.1)(D, F) * (2.0 / D) ** 0.5),
            "W_down": _w((lambda *s: torch.randn(*s, dtype=torch.bfloat16) * 0.1)(F, D) * (1.0 / F) ** 0.5),
        }
    _B_in = _B_setup()

    return {
        "A_x": _A_in["x"],
        "A_wqkv": _A_in["wqkv"],
        "A_wo": _A_in["wo"],
        "B_x": _B_in["x"],
        "B_W_gate": _B_in["W_gate"],
        "B_W_up": _B_in["W_up"],
        "B_W_down": _B_in["W_down"],
    }

def reference(A_x, A_wqkv, A_wo, B_x, B_W_gate, B_W_up, B_W_down):
    def _A_ref(x, wqkv, wo):
        B, S, D = x.shape
        H = 32
        Dh = D // H
        qkv = (lambda x, *d: x.permute(*d))((x @ wqkv).reshape(B, S, 3, H, Dh), 2, 0, 3, 1, 4)
        q, k, v = qkv[0], qkv[1], qkv[2]
        scores = torch.einsum("bhqd,bhkd->bhqk", q, k) * (Dh ** -0.5)
        p = _softmax(scores, axis=-1)
        o = torch.einsum("bhqk,bhkd->bhqd", p, v)
        return (lambda x, *d: x.permute(*d))(o, 0, 2, 1, 3).reshape(B, S, D) @ wo

    def _B_ref(x, W_gate, W_up, W_down):
        gate = torch.einsum("bsd,df->bsf", x, W_gate)
        up = torch.einsum("bsd,df->bsf", x, W_up)
        gate = gate * (lambda x, dt: x.to(dt))(gate > 0, gate.dtype)
        h = gate * up
        return torch.einsum("bsf,fd->bsd", h, W_down)

    x = A_x
    xn = _layernorm(x, axis=-1)
    s = _A_ref(xn, A_wqkv, A_wo)
    g = _silu(_B_ref(xn, B_W_gate, B_W_up, B_W_down))
    return x + s * g
```

```asm
; @launch grid=(256,1,1) block=(512,1,1) lds=163840
.amdgcn_target "amdgcn-amd-amdhsa--gfx950"
.text
.globl recurrent_scan__mha_block__glu_gated_reglu__prompt_kernel
.p2align 8
.type recurrent_scan__mha_block__glu_gated_reglu__prompt_kernel,@function
recurrent_scan__mha_block__glu_gated_reglu__prompt_kernel:
    s_cmp_ge_u32 s2, 256
    s_cbranch_scc1 M_end
    s_load_dwordx4 s[4:7], s[0:1], 0
    s_getpc_b64 s[60:61]
M_pc0:
    v_lshlrev_b32 v1, 6, v0
    s_mov_b32 s62, M_codeend-M_pc0
    s_mov_b32 s63, 0x20000
    v_readfirstlane_b32 s28, v0
    buffer_load_dword v254, v1, s[60:63], 0 offen
    s_bfe_u32 s31, s2, 0x30003
    s_and_b32 s3, s2, 1
    s_lshl3_add_u32 s31, s3, s31
    s_and_b32 s3, s2, 6
    s_lshr_b32 s100, s2, 7
    s_add_u32 s100, s100, s3
    s_lshr_b32 s32, s31, 2
    s_lshl1_add_u32 s32, s32, s3
    s_and_b32 s32, s32, 7
    v_and_b32 v255, 63, v0
    s_bfe_u32 s28, s28, 0x20006
    v_cmp_gt_u32 vcc, 256, v0
    s_mov_b32 s42, 0x200000
    s_mov_b32 s43, 0x20000
    v_lshrrev_b32 v2, 3, v255
    s_cbranch_vccz M_L
    s_lshl3_add_u32 s52, s31, s100
    s_bfe_u32 s3, s2, 0x10006
    s_lshl1_add_u32 s52, s52, s3
    s_lshl2_add_u32 s52, s52, s28
    v_lshlrev_b32 v251, 4, v255
    s_lshl_b32 s51, s52, 11
    s_waitcnt lgkmcnt(0)
    s_mov_b64 s[40:41], s[4:5]
    buffer_load_dwordx4 v[160:163], v251, s[40:43], s51 offen
    buffer_load_dwordx4 v[164:167], v251, s[40:43], s51 offen offset:1024
    s_branch M_C
M_L:
    v_lshrrev_b32 v3, 4, v255
    v_and_b32 v4, 7, v255
    s_lshl_b32 s3, s31, 2
    s_add_u32 s3, s3, s28
    s_lshl_b32 s3, s3, 15
    v_lshl_add_u32 v6, v2, 10, s3
    v_xor_b32 v5, v3, v4
    v_lshl_add_u32 v16, v5, 4, v6
    v_xor_b32 v17, 0x2040, v16
    v_add_u32 v18, 16384, v16
    v_add_u32 v19, 16384, v17
    s_lshl_b32 s74, s32, 7
    s_lshl_b32 s75, s28, 12
    s_add_u32 s76, s75, 65536
    s_add_u32 s68, s76, 81920
    s_mov_b32 s69, s76
    s_waitcnt lgkmcnt(0)
    s_mov_b64 s[40:41], s[4:5]
    s_getpc_b64 s[10:11]
M_qx:
    s_add_u32 s10, s10, M_rx-M_qx
    s_addc_u32 s11, s11, 0
M_gx:
    s_add_u32 m0, s76, 0
    s_nop 0
    buffer_load_dwordx4 v16, s[40:43], s74 offen  lds
    s_add_u32 m0, s76, 1024
    s_nop 0
    buffer_load_dwordx4 v17, s[40:43], s74 offen  lds
    s_add_u32 m0, s76, 2048
    s_nop 0
    buffer_load_dwordx4 v18, s[40:43], s74 offen  lds
    s_add_u32 m0, s76, 3072
    s_nop 0
    buffer_load_dwordx4 v19, s[40:43], s74 offen  lds
    s_add_u32 s74, s74, 128
    s_and_b32 s74, s74, 1023
    s_add_u32 s76, s76, 16384
    s_cmp_eq_u32 s76, s68
    s_cselect_b32 s76, s69, s76
    s_setpc_b64 s[10:11]
M_rx:
    s_mov_b64 s[44:45], s[6:7]
    s_mov_b32 s46, 1572864
    s_mov_b32 s47, 0x20000
    v_and_b32 v5, 1, v3
    v_lshlrev_b32 v5, 2, v5
    v_xor_b32 v5, v5, v4
    v_lshlrev_b32 v12, 4, v5
    s_lshl_b32 s3, s28, 4
    v_add_u32 v13, s3, v2
    s_mov_b32 s66, s100
    s_bfe_u32 s30, s2, 0x10006
    s_lshl_b32 s3, s66, 7
    s_lshl_b32 s77, s30, 10
    s_add_u32 s3, s3, s77
    v_add_u32 v5, s3, v12
    s_movk_i32 s3, 3072
    v_mad_u32_u24 v10, v13, s3, v5
    v_add_u32 v11, 24576, v10
    s_mul_i32 s64, s32, 196608
    s_getpc_b64 s[10:11]
M_qA:
    s_add_u32 s10, s10, M_rA-M_qA
    s_addc_u32 s11, s11, 0
M_gA:
    s_mov_b32 m0, s75
    s_cmp_eq_u32 s30, 1
    buffer_load_dwordx4 v10, s[44:47], s64 offen  lds
    s_cbranch_scc1 M_ga1
    buffer_load_dwordx4 v10, s[44:47], s64 offen offset:2048  lds
M_ga1:
    s_add_u32 m0, s75, 1024
    s_cmp_eq_u32 s30, 1
    buffer_load_dwordx4 v11, s[44:47], s64 offen  lds
    s_cbranch_scc1 M_ga2
    buffer_load_dwordx4 v11, s[44:47], s64 offen offset:2048  lds
M_ga2:
    s_add_u32 s64, s64, 196608
    s_cmp_eq_u32 s64, 1572864
    s_cselect_b32 s64, 0, s64
    s_add_u32 s75, s75, 16384
    s_and_b32 s75, s75, 65535
    s_setpc_b64 s[10:11]
M_rA:
    s_call_b64 s[10:11], M_gx
    s_call_b64 s[10:11], M_gA
    s_load_dwordx8 s[12:19], s[0:1], 32
    s_load_dwordx2 s[8:9], s[0:1], 16
    s_load_dwordx4 s[20:23], s[0:1], 64
    s_and_b32 s29, s2, 7
    s_lshl_b32 s33, s29, 2
    s_lshl_b32 s29, s100, 1
    s_bfe_u32 s30, s2, 0x10006
    s_add_u32 s29, s29, s30
    s_and_b32 s101, s31, 3
    s_bfe_u32 s3, s2, 0x20003
    s_add_u32 s33, s33, s3
    s_lshr_b32 s34, s2, 5
    s_mov_b32 s26, 17825792
    s_mov_b32 s27, 0x20000
    s_and_b32 s36, s28, 1
    s_lshr_b32 s37, s28, 1
    s_waitcnt vmcnt(8)
    s_cmp_eq_u32 s30, 0
    s_cbranch_scc1 LW_1
    s_waitcnt vmcnt(6)
LW_1:
    s_barrier
    s_call_b64 s[10:11], M_gx
    s_call_b64 s[10:11], M_gA
    s_mov_b32 s50, 1835008
    s_mov_b32 s51, 0x20000
    s_mov_b32 s55, 0x20000
    s_and_b32 s67, s66, 1
    s_mul_i32 s66, s66, 448
    s_lshl_b32 s3, s67, 6
    s_sub_u32 s66, s66, s3
    s_xor_b32 s67, s67, s30
    s_xor_b32 s67, s67, 1
    s_lshl_b32 s67, s67, 8
    s_add_u32 s66, s66, s67
    s_mul_i32 s3, s36, 57344
    s_add_u32 s66, s66, s3
    s_lshl_b32 s3, s37, 2
    v_add_u32 v7, s3, v3
    v_lshlrev_b32 v7, 1, v7
    v_and_b32 v5, 15, v255
    v_xor_b32 v7, v7, v5
    v_lshlrev_b32 v14, 4, v7
    v_add_u32 v5, s66, v14
    s_movk_i32 s3, 3584
    v_mad_u32_u24 v20, v3, s3, v5
    s_add_u32 s65, s32, 3
    s_and_b32 s65, s65, 7
    s_mul_i32 s65, s65, 229376
    s_waitcnt lgkmcnt(0)
    s_mov_b64 s[24:25], s[22:23]
    s_cmp_eq_u32 s37, 0
    s_cselect_b32 s48, s12, s14
    s_cselect_b32 s49, s13, s15
    v_mov_b32 v4, 161280
    s_lshl_b32 s71, s29, 4
    s_add_u32 s71, s71, s31
    s_mul_i32 s71, s71, 384
    s_add_u32 s70, s71, 15925248
    s_add_u32 s73, s71, 15728640
    s_mul_i32 s38, s29, 12288
    s_add_u32 s38, s38, 16023552
    s_waitcnt vmcnt(8)
    s_cmp_eq_u32 s30, 0
    s_cbranch_scc1 LW_2
    s_waitcnt vmcnt(6)
LW_2:
    s_barrier
    s_call_b64 s[10:11], M_gx
    s_call_b64 s[10:11], M_gA
    s_call_b64 s[10:11], M_gx
    s_call_b64 s[10:11], M_gA
    s_waitcnt vmcnt(16)
    s_cmp_eq_u32 s30, 0
    s_cbranch_scc1 LW_3
    s_waitcnt vmcnt(12)
LW_3:
    s_barrier
    s_call_b64 s[10:11], M_gx
    s_call_b64 s[10:11], M_gA
    s_waitcnt vmcnt(16)
    s_cmp_eq_u32 s30, 0
    s_cbranch_scc1 LW_4
    s_waitcnt vmcnt(12)
LW_4:
    s_barrier
    s_cmp_lg_u32 s28, 0
    s_cbranch_scc1 M_tg0
    s_load_dword s35, s[20:21], 0
M_tg0:
    s_call_b64 s[10:11], M_gx
    s_call_b64 s[10:11], M_gA
    s_waitcnt vmcnt(16)
    s_cmp_eq_u32 s30, 0
    s_cbranch_scc1 LW_5
    s_waitcnt vmcnt(12)
LW_5:
    s_barrier
    s_cmp_lg_u32 s28, 0
    s_cbranch_scc1 M_la2
    s_waitcnt lgkmcnt(0)
    s_cmp_lg_u32 s35, 0
    s_cbranch_scc1 M_tgd
    s_sleep 8
    s_load_dword s35, s[20:21], 128
    s_waitcnt lgkmcnt(0)
    s_cmp_lg_u32 s35, 0
    s_cbranch_scc1 M_tgd
    s_sleep 8
    s_load_dword s35, s[20:21], 64
    s_waitcnt lgkmcnt(0)
    s_cmp_lg_u32 s35, 0
    s_cbranch_scc1 M_tgd
    s_sleep 8
    s_load_dword s35, s[20:21], 192
    s_mov_b32 s3, 200000
M_tg:
    s_waitcnt lgkmcnt(0)
    s_cmp_lg_u32 s35, 0
    s_cbranch_scc1 M_tgd
    s_sleep 8
    s_load_dword s35, s[20:21], 0 glc
    s_sub_u32 s3, s3, 1
    s_cmp_lg_u32 s3, 0
    s_cbranch_scc1 M_tg
    s_waitcnt lgkmcnt(0)
M_tgd:
    v_mov_b32 v5, s35
    s_mov_b64 exec, 1
    buffer_store_dword v5, off, s[24:27], s70 sc1
    s_mov_b64 exec, -1
    ds_write_b32 v4, v5
    s_waitcnt lgkmcnt(0)
M_la2:
    s_call_b64 s[10:11], M_gx
    s_call_b64 s[10:11], M_gA
    s_waitcnt vmcnt(16)
    s_cmp_eq_u32 s30, 0
    s_cbranch_scc1 LW_6
    s_waitcnt vmcnt(12)
LW_6:
    s_barrier
    ds_read_b32 v4, v4
    s_waitcnt lgkmcnt(0)
    v_readfirstlane_b32 s35, v4
    s_call_b64 s[10:11], M_gW
    s_waitcnt vmcnt(12)
    s_cmp_eq_u32 s30, 0
    s_cbranch_scc1 LW_7
    s_waitcnt vmcnt(10)
LW_7:
    s_barrier
    s_call_b64 s[10:11], M_gW
    v_lshlrev_b32 v2, 4, v255
    v_and_b32 v5, 15, v255
    s_lshl_b32 s3, s29, 4
    v_add_u32 v6, s3, v5
    v_lshl_add_u32 v7, v5, 4, s31
    v_and_b32 v21, 16, v255
    v_cmp_eq_u32 vcc, 0, v21
    s_mov_b32 s72, 15925248
    s_nop 0
    v_cndmask_b32 v21, v7, v6, vcc
    v_mul_u32_u24 v21, 384, v21
    v_bfe_u32 v24, v255, 4, 1
    v_lshl_add_u32 v24, v5, 5, v24
    v_mul_u32_u24 v24, 768, v24
    s_movk_i32 s3, 768
    v_lshrrev_b32 v5, 3, v255
    v_mad_u32_u24 v22, v5, s3, v12
    v_mul_u32_u24 v25, 384, v6
    v_lshrrev_b32 v5, 4, v255
    v_mad_u32_u24 v23, v5, s3, v14
    s_lshl_b32 s3, s37, 8
    s_add_u32 s3, s3, 256
    v_add_u32 v23, s3, v23
    v_and_b32 v3, 31, v255
    v_mul_u32_u24 v3, 384, v3
    s_waitcnt vmcnt(8)
    s_barrier
    s_call_b64 s[10:11], M_gW
    s_waitcnt vmcnt(8)
    s_barrier
    buffer_load_dword v26, v21, s[24:27], s72 offen sc1
    s_call_b64 s[10:11], M_gW
    s_waitcnt vmcnt(9)
    s_barrier
    s_call_b64 s[10:11], M_gW
    s_waitcnt vmcnt(9)
    s_barrier
    s_waitcnt vmcnt(8)
    v_cmp_ne_u32 vcc, s35, v26
    s_cbranch_vccz M_ps_ok
    s_mov_b32 s3, 200000
M_ps:
    buffer_load_dword v5, v21, s[24:27], s72 offen sc1
    s_waitcnt vmcnt(0)
    v_cmp_ne_u32 vcc, s35, v5
    s_cbranch_vccz M_ps_ok
    s_sleep 2
    s_sub_u32 s3, s3, 1
    s_cmp_lg_u32 s3, 0
    s_cbranch_scc1 M_ps
M_ps_ok:
    s_lshl_b32 s3, s28, 10
    s_add_u32 m0, s3, 151552
    s_mul_i32 s3, s36, 6144
    s_lshl_b32 s66, s37, 7
    s_add_u32 s3, s3, s66
    s_add_u32 s3, s3, s38
    buffer_load_dwordx4 v22, s[24:27], s3 offen sc1 lds
    s_cmp_lg_u32 s28, 3
    s_cbranch_scc1 M_nots
    s_mov_b32 m0, 159744
    s_lshl_b32 s3, s31, 10
    s_add_u32 s3, s3, 16220160
    buffer_load_dwordx4 v2, s[24:27], s3 offen sc1 lds
M_nots:
    s_call_b64 s[10:11], M_gW
    s_waitcnt vmcnt(9)
    s_barrier
    s_call_b64 s[10:11], M_gW
    s_waitcnt vmcnt(8)
    s_barrier
    s_call_b64 s[10:11], M_gW
    s_lshl_b32 s56, s28, 13
    s_add_u32 s56, s56, 131072
    s_lshl_b32 s57, s34, 7
    v_lshrrev_b32 v60, 5, v255
    v_bfe_u32 v61, v255, 2, 2
    v_lshl_add_u32 v60, v60, 2, v61
    v_lshlrev_b32 v56, 7, v60
    v_bfe_u32 v60, v60, 1, 1
    v_lshl_add_u32 v56, v60, 6, v56
    v_bfe_u32 v60, v255, 4, 1
    v_lshl_add_u32 v56, v60, 5, v56
    v_and_b32 v60, 3, v255
    v_lshl_add_u32 v56, v60, 3, v56
    v_add_u32 v56, s56, v56
    v_xor_b32 v57, 64, v56
    v_lshrrev_b32 v60, 3, v255
    v_bfe_u32 v61, v255, 4, 1
    v_lshlrev_b32 v61, 2, v61
    v_and_b32 v58, 7, v255
    v_xor_b32 v58, v58, v61
    v_lshlrev_b32 v58, 4, v58
    v_lshl_add_u32 v58, v60, 10, v58
    v_add_u32 v58, s57, v58
    v_add_u32 v59, 8192, v58
    v_subrev_u32 v54, 131072, v56
    v_subrev_u32 v55, 131072, v57
    v_mov_b64 v[64:65], 0
    v_mov_b64 v[66:67], 0
    v_mov_b64 v[68:69], 0
    v_mov_b64 v[70:71], 0
    v_mov_b64 v[72:73], 0
    v_mov_b64 v[74:75], 0
    v_mov_b64 v[76:77], 0
    v_mov_b64 v[78:79], 0
    v_mov_b64 v[80:81], 0
    v_mov_b64 v[82:83], 0
    v_mov_b64 v[84:85], 0
    v_mov_b64 v[86:87], 0
    v_mov_b64 v[88:89], 0
    v_mov_b64 v[90:91], 0
    v_mov_b64 v[92:93], 0
    v_mov_b64 v[94:95], 0
    v_mov_b64 v[96:97], 0
    v_mov_b64 v[98:99], 0
    v_mov_b64 v[100:101], 0
    v_mov_b64 v[102:103], 0
    v_mov_b64 v[104:105], 0
    v_mov_b64 v[106:107], 0
    v_mov_b64 v[108:109], 0
    v_mov_b64 v[110:111], 0
    v_mov_b64 v[112:113], 0
    v_mov_b64 v[114:115], 0
    v_mov_b64 v[116:117], 0
    v_mov_b64 v[118:119], 0
    v_mov_b64 v[120:121], 0
    v_mov_b64 v[122:123], 0
    v_mov_b64 v[124:125], 0
    v_mov_b64 v[126:127], 0
    s_lshl_b32 s3, s28, 13
    v_and_b32 v60, 31, v255
    v_lshrrev_b32 v61, 5, v255
    v_and_b32 v62, 15, v255
    v_xor_b32 v63, v61, v62
    v_lshlrev_b32 v63, 4, v63
    v_lshl_add_u32 v63, v60, 8, v63
    v_add_u32 v192, s3, v63
    v_add_u32 v200, s56, v63
    v_xor_b32 v193, 32, v192
    v_xor_b32 v194, 64, v192
    v_xor_b32 v195, 96, v192
    v_xor_b32 v196, 128, v192
    v_xor_b32 v197, 160, v192
    v_xor_b32 v198, 192, v192
    v_xor_b32 v199, 224, v192
    v_xor_b32 v201, 32, v200
    v_xor_b32 v202, 64, v200
    v_xor_b32 v203, 96, v200
    v_xor_b32 v204, 128, v200
    v_xor_b32 v205, 160, v200
    v_xor_b32 v206, 192, v200
    v_xor_b32 v207, 224, v200
    v_lshlrev_b32 v6, 1, v61
    s_lshl_b32 s3, s36, 3
    v_add_u32 v6, s3, v6
    v_xor_b32 v6, v6, v62
    v_lshlrev_b32 v6, 4, v6
    v_lshl_add_u32 v6, v60, 8, v6
    s_mul_i32 s3, s37, 131072
    v_add_u32 v208, s3, v6
    v_xor_b32 v209, 16, v208
    v_xor_b32 v210, 64, v208
    v_xor_b32 v211, 64, v209
    s_lshl_b32 s3, s36, 2
    v_add_u32 v6, s3, v61
    v_and_b32 v7, 7, v255
    v_xor_b32 v6, v6, v7
    v_lshlrev_b32 v6, 4, v6
    v_lshl_add_u32 v6, v60, 7, v6
    s_lshl_b32 s3, s37, 12
    s_add_u32 s3, s3, 132096
    v_add_u32 v248, s3, v6
    v_xor_b32 v249, 32, v248
    s_lshl_b32 s3, s28, 11
    s_add_u32 s3, s3, 132096
    v_add_u32 v250, s3, v2
    v_lshrrev_b32 v6, 3, v255
    v_xor_b32 v7, v7, v6
    v_lshlrev_b32 v7, 4, v7
    v_lshl_add_u32 v251, v6, 10, v7
    v_lshlrev_b32 v61, 4, v61
    v_lshl_add_u32 v212, v60, 10, v61
    s_sub_u32 s3, 0x8000, s56
    v_add_u32 v214, s3, v56
    s_lshl_b32 s3, s36, 6
    v_xor_b32 v214, s3, v214
    s_mul_i32 s3, s37, 131072
    v_add_u32 v215, s3, v2
    v_mov_b64 v[216:217], 0
    v_mov_b64 v[218:219], 0
    v_mov_b64 v[220:221], 0
    v_mov_b64 v[222:223], 0
    v_mov_b64 v[224:225], 0
    v_mov_b64 v[226:227], 0
    v_mov_b64 v[228:229], 0
    v_mov_b64 v[230:231], 0
    s_waitcnt vmcnt(8)
    s_barrier
    s_call_b64 s[10:11], M_gW
    s_waitcnt vmcnt(8)
    s_barrier
    s_call_b64 s[10:11], M_gW
    s_waitcnt vmcnt(8)
    s_barrier
    s_call_b64 s[10:11], M_gx
    s_call_b64 s[10:11], M_gW
    s_waitcnt vmcnt(12)
    s_barrier
    s_cmp_lg_u32 s28, 0
    s_cbranch_scc1 M_nofq
    v_mov_b32 v5, s35
    s_mov_b64 exec, 1
    buffer_store_dword v5, off, s[24:27], s73 sc1
    s_mov_b64 exec, -1
M_nofq:
    s_call_b64 s[10:11], M_gW
    s_waitcnt vmcnt(12)
    s_barrier
    s_call_b64 s[10:11], M_gx
    s_call_b64 s[10:11], M_gW
    s_waitcnt vmcnt(12)
    s_barrier
    s_call_b64 s[10:11], M_gW
    s_waitcnt vmcnt(12)
    s_barrier
    s_call_b64 s[10:11], M_gx
    s_call_b64 s[10:11], M_gW
    s_waitcnt vmcnt(12)
    s_barrier
    s_call_b64 s[10:11], M_gW
    s_waitcnt vmcnt(12)
    s_barrier
    s_waitcnt vmcnt(4)
    s_barrier
    s_waitcnt vmcnt(0)
    s_cmp_eq_u32 s36, 1
    s_cbranch_scc1 M_lh
    s_mov_b32 s72, 15728640
    s_mov_b32 s3, 200000
M_pb:
    buffer_load_dword v5, v25, s[24:27], s72 offen sc1
    s_waitcnt vmcnt(0)
    v_cmp_ne_u32 vcc, s35, v5
    s_cbranch_vccz M_pb_ok
    s_sleep 2
    s_sub_u32 s3, s3, 1
    s_cmp_lg_u32 s3, 0
    s_cbranch_scc1 M_pb
M_pb_ok:
    s_add_u32 m0, s75, 147456
    s_add_u32 s66, s38, 0
    buffer_load_dwordx4 v23, s[24:27], s66 offen sc1 lds
    s_add_u32 m0, s75, 148480
    s_add_u32 s66, s38, 3072
    buffer_load_dwordx4 v23, s[24:27], s66 offen sc1 lds
    s_add_u32 m0, s75, 149504
    s_add_u32 s66, s38, 6144
    buffer_load_dwordx4 v23, s[24:27], s66 offen sc1 lds
    s_add_u32 m0, s75, 150528
    s_add_u32 s66, s38, 9216
    buffer_load_dwordx4 v23, s[24:27], s66 offen sc1 lds
M_lh:
    s_lshr_b32 s69, s33, 2
    s_mul_i32 s69, s69, 12288
    s_add_u32 s69, s69, 15728640
    s_cmp_lg_u32 s28, 1
    s_cbranch_scc1 M_pq_ok
    s_mov_b32 s3, 200000
M_pq:
    buffer_load_dword v5, v3, s[24:27], s69 offen sc1
    s_waitcnt vmcnt(0)
    v_cmp_ne_u32 vcc, s35, v5
    s_cbranch_vccz M_pq_ok
    s_sleep 2
    s_sub_u32 s3, s3, 1
    s_cmp_lg_u32 s3, 0
    s_cbranch_scc1 M_pq
M_pq_ok:
    s_waitcnt vmcnt(4)
    s_barrier
    s_lshl_b32 s3, s34, 2
    s_add_u32 s3, s3, s28
    s_lshl_b32 s66, s33, 5
    s_add_u32 s3, s3, s66
    s_lshl_b32 s3, s3, 11
    s_add_u32 s3, s3, 0
    s_lshl_b32 s66, s33, 17
    s_add_u32 s66, s66, 2097152
    buffer_load_dwordx4 v[128:131], v2, s[24:27], s3 offen sc1
    buffer_load_dwordx4 v[132:135], v2, s[24:27], s3 offen offset:1024 sc1
    buffer_load_dwordx4 v[136:139], v2, s[24:27], s66 offen sc1
    buffer_load_dwordx4 v[140:143], v2, s[24:27], s66 offen offset:2048 sc1
    s_lshl_b32 s71, s28, 10
    s_add_u32 s72, s66, s71
    s_mov_b32 s3, 4
M_kv0:
    s_mov_b32 m0, s71
    s_add_u32 s71, s71, 4096
    buffer_load_dwordx4 v2, s[24:27], s72 offen sc1 lds
    s_add_u32 s72, s72, 4096
    s_sub_u32 s3, s3, 1
    s_cmp_lg_u32 s3, 0
    s_cbranch_scc1 M_kv0
    s_waitcnt vmcnt(8)
    s_barrier
    s_branch M_lb
M_gW:
    s_add_u32 m0, s75, 0
    s_add_u32 s66, s65, 0
    buffer_load_dwordx4 v20, s[48:51], s66 offen  lds
    s_add_u32 m0, s75, 1024
    s_add_u32 s66, s65, 14336
    buffer_load_dwordx4 v20, s[48:51], s66 offen  lds
    s_add_u32 m0, s75, 2048
    s_add_u32 s66, s65, 28672
    buffer_load_dwordx4 v20, s[48:51], s66 offen  lds
    s_add_u32 m0, s75, 3072
    s_add_u32 s66, s65, 43008
    buffer_load_dwordx4 v20, s[48:51], s66 offen  lds
    s_add_u32 s65, s65, 114688
    s_cmp_eq_u32 s65, 1835008
    s_cselect_b32 s65, 0, s65
    s_add_u32 s75, s75, 16384
    s_and_b32 s75, s75, 65535
    s_setpc_b64 s[10:11]
M_lb:
    s_mov_b32 s3, 5
M_kv1:
    s_mov_b32 m0, s71
    s_add_u32 s71, s71, 4096
    buffer_load_dwordx4 v2, s[24:27], s72 offen sc1 lds
    s_add_u32 s72, s72, 4096
    s_sub_u32 s3, s3, 1
    s_cmp_lg_u32 s3, 0
    s_cbranch_scc1 M_kv1
    s_setprio 0
    s_waitcnt vmcnt(9)
    v_mfma_f32_32x32x16_bf16 v[144:159], v[136:139], v[128:131], 0
    v_mfma_f32_32x32x16_bf16 v[160:175], v[140:143], v[128:131], 0
    v_mfma_f32_32x32x16_bf16 v[176:191], v[136:139], v[132:135], 0
    v_mfma_f32_32x32x16_bf16 v[232:247], v[140:143], v[132:135], 0
    s_lshl_b32 s3, s28, 12
    s_add_u32 s3, s3, 131072
    v_add_u32 v62, s3, v2
    ds_write_b128 v62, v[128:131]
    ds_write_b128 v62, v[132:135] offset:1024
    s_nop 3
    v_max3_f32 v60, v144, v145, v146
    v_max3_f32 v60, v60, v147, v148
    v_max3_f32 v60, v60, v149, v150
    v_max3_f32 v60, v60, v151, v152
    v_max3_f32 v60, v60, v153, v154
    v_max3_f32 v60, v60, v155, v156
    v_max3_f32 v60, v60, v157, v158
    v_max3_f32 v60, v60, v159, v160
    v_max3_f32 v60, v60, v161, v162
    v_max3_f32 v60, v60, v163, v164
    v_max3_f32 v60, v60, v165, v166
    v_max3_f32 v60, v60, v167, v168
    v_max3_f32 v60, v60, v169, v170
    v_max3_f32 v60, v60, v171, v172
    v_max3_f32 v60, v60, v173, v174
    v_max_f32 v60, v60, v175
    v_max3_f32 v61, v176, v177, v178
    v_max3_f32 v61, v61, v179, v180
    v_max3_f32 v61, v61, v181, v182
    v_max3_f32 v61, v61, v183, v184
    v_max3_f32 v61, v61, v185, v186
    v_max3_f32 v61, v61, v187, v188
    v_max3_f32 v61, v61, v189, v190
    v_max3_f32 v61, v61, v191, v232
    v_max3_f32 v61, v61, v233, v234
    v_max3_f32 v61, v61, v235, v236
    v_max3_f32 v61, v61, v237, v238
    v_max3_f32 v61, v61, v239, v240
    v_max3_f32 v61, v61, v241, v242
    v_max3_f32 v61, v61, v243, v244
    v_max3_f32 v61, v61, v245, v246
    v_max_f32 v61, v61, v247
    s_lshl_b32 s3, s28, 12
    s_add_u32 s3, s3, 133120
    v_permlane32_swap_b32 v60, v61
    v_lshl_add_u32 v62, v255, 3, s3
    s_nop 0
    v_max_f32 v60, v60, v61
    v_sub_f32 v60, 0xc2c00000, v60
    v_mul_f32 v60, 0x3e000000, v60
    v_cvt_pk_bf16_f32 v60, v60, v60
    v_mov_b32 v61, v60
    ds_write_b64 v62, v[60:61]
    s_setprio 0
    s_waitcnt vmcnt(0) lgkmcnt(0)
    s_barrier
    s_mov_b32 s3, 23
M_kv2:
    s_mov_b32 m0, s71
    s_add_u32 s71, s71, 4096
    buffer_load_dwordx4 v2, s[24:27], s72 offen sc1 lds
    s_add_u32 s72, s72, 4096
    s_sub_u32 s3, s3, 1
    s_cmp_lg_u32 s3, 0
    s_cbranch_scc1 M_kv2
    s_mov_b64 s[44:45], s[16:17]
    s_mov_b32 s46, 1835008
    s_mov_b64 s[48:49], s[8:9]
    s_mov_b32 s50, 524288
    s_mov_b64 s[52:53], s[18:19]
    s_mov_b32 s54, 0x200000
    s_lshl_b32 s64, s28, 13
    s_add_u32 s64, s64, 131072
    s_lshl_b32 s65, s34, 7
    s_mul_i32 s66, s28, 458752
    s_mul_i32 s67, s33, 229376
    s_mul_i32 s68, s28, 28672
    s_add_u32 s67, s67, s68
    s_add_u32 s67, s67, 6291456
    s_add_u32 s68, s67, 114688
    s_lshr_b32 s70, s33, 1
    s_lshl_b32 s70, s70, 2
    s_and_b32 s3, s33, 1
    s_add_u32 s70, s70, s3
    s_mul_i32 s70, s70, 384
    s_add_u32 s70, s70, 16646144
    s_waitcnt vmcnt(0)
    s_barrier
    s_mov_b32 s3, 200000
M_ph:
    buffer_load_dword v5, v24, s[24:27], s70 offen sc1
    s_waitcnt vmcnt(0)
    v_cmp_ne_u32 vcc, s35, v5
    s_cbranch_vccz M_ph_ok
    s_sleep 2
    s_sub_u32 s3, s3, 1
    s_cmp_lg_u32 s3, 0
    s_cbranch_scc1 M_ph
M_ph_ok:
    s_add_u32 m0, s64, 0
    s_nop 0
    buffer_load_dwordx4 v58, s[44:47], s66 offen lds
    s_add_u32 m0, s64, 1024
    s_nop 0
    buffer_load_dwordx4 v59, s[44:47], s66 offen lds
    buffer_load_dwordx4 v[128:131], v2, s[24:27], s67 offen sc1
    buffer_load_dwordx4 v[132:135], v2, s[24:27], s68 offen sc1
    s_add_u32 s66, s66, 16384
    s_add_u32 s67, s67, 1024
    s_add_u32 s68, s68, 1024
    s_add_u32 m0, s64, 2048
    s_nop 0
    buffer_load_dwordx4 v58, s[44:47], s66 offen lds
    s_add_u32 m0, s64, 3072
    s_nop 0
    buffer_load_dwordx4 v59, s[44:47], s66 offen lds
    buffer_load_dwordx4 v[136:139], v2, s[24:27], s67 offen sc1
    buffer_load_dwordx4 v[140:143], v2, s[24:27], s68 offen sc1
    s_add_u32 s66, s66, 16384
    s_add_u32 s67, s67, 1024
    s_add_u32 s68, s68, 1024
    s_add_u32 m0, s64, 4096
    s_nop 0
    buffer_load_dwordx4 v58, s[44:47], s66 offen lds
    s_add_u32 m0, s64, 5120
    s_nop 0
    buffer_load_dwordx4 v59, s[44:47], s66 offen lds
    buffer_load_dwordx4 v[144:147], v2, s[24:27], s67 offen sc1
    buffer_load_dwordx4 v[148:151], v2, s[24:27], s68 offen sc1
    s_add_u32 s66, s66, 16384
    s_add_u32 s67, s67, 1024
    s_add_u32 s68, s68, 1024
    s_add_u32 m0, s64, 6144
    s_nop 0
    buffer_load_dwordx4 v58, s[44:47], s66 offen lds
    s_add_u32 m0, s64, 7168
    s_nop 0
    buffer_load_dwordx4 v59, s[44:47], s66 offen lds
    buffer_load_dwordx4 v[152:155], v2, s[24:27], s67 offen sc1
    buffer_load_dwordx4 v[156:159], v2, s[24:27], s68 offen sc1
    s_add_u32 s66, s66, 16384
    s_add_u32 s67, s67, 1024
    s_add_u32 s68, s68, 1024
    s_add_u32 m0, s64, 4294836224
    s_nop 0
    buffer_load_dwordx4 v58, s[44:47], s66 offen lds
    s_add_u32 m0, s64, 4294837248
    s_nop 0
    buffer_load_dwordx4 v59, s[44:47], s66 offen lds
    buffer_load_dwordx4 v[160:163], v2, s[24:27], s67 offen sc1
    buffer_load_dwordx4 v[164:167], v2, s[24:27], s68 offen sc1
    s_add_u32 s66, s66, 16384
    s_add_u32 s67, s67, 1024
    s_add_u32 s68, s68, 1024
    s_add_u32 m0, s64, 4294838272
    s_nop 0
    buffer_load_dwordx4 v58, s[44:47], s66 offen lds
    s_add_u32 m0, s64, 4294839296
    s_nop 0
    buffer_load_dwordx4 v59, s[44:47], s66 offen lds
    buffer_load_dwordx4 v[168:171], v2, s[24:27], s67 offen sc1
    buffer_load_dwordx4 v[172:175], v2, s[24:27], s68 offen sc1
    s_add_u32 s66, s66, 16384
    s_add_u32 s67, s67, 1024
    s_add_u32 s68, s68, 1024
    s_add_u32 m0, s64, 4294840320
    s_nop 0
    buffer_load_dwordx4 v58, s[44:47], s66 offen lds
    s_add_u32 m0, s64, 4294841344
    s_nop 0
    buffer_load_dwordx4 v59, s[44:47], s66 offen lds
    buffer_load_dwordx4 v[176:179], v2, s[24:27], s67 offen sc1
    buffer_load_dwordx4 v[180:183], v2, s[24:27], s68 offen sc1
    s_add_u32 s66, s66, 16384
    s_add_u32 s67, s67, 1024
    s_add_u32 s68, s68, 1024
    s_mov_b32 s77, 3
    s_setprio 0
M_gloop:
    s_waitcnt vmcnt(24)
    ds_read_b64_tr_b16 v[40:41], v56 offset:0
    ds_read_b64_tr_b16 v[42:43], v56 offset:1024
    ds_read_b64_tr_b16 v[44:45], v57 offset:0
    ds_read_b64_tr_b16 v[46:47], v57 offset:1024
    s_waitcnt lgkmcnt(2)
    v_mfma_f32_32x32x16_bf16 v[64:79], v[40:43], v[128:131], v[64:79]
    v_mfma_f32_32x32x16_bf16 v[80:95], v[40:43], v[132:135], v[80:95]
    s_waitcnt lgkmcnt(0)
    v_mfma_f32_32x32x16_bf16 v[96:111], v[44:47], v[128:131], v[96:111]
    v_mfma_f32_32x32x16_bf16 v[112:127], v[44:47], v[132:135], v[112:127]
    s_add_u32 m0, s64, 0
    s_nop 0
    buffer_load_dwordx4 v58, s[44:47], s66 offen lds
    s_add_u32 m0, s64, 1024
    s_nop 0
    buffer_load_dwordx4 v59, s[44:47], s66 offen lds
    buffer_load_dwordx4 v[128:131], v2, s[24:27], s67 offen sc1
    buffer_load_dwordx4 v[132:135], v2, s[24:27], s68 offen sc1
    s_add_u32 s66, s66, 16384
    s_add_u32 s67, s67, 1024
    s_add_u32 s68, s68, 1024
    s_waitcnt vmcnt(24)
    ds_read_b64_tr_b16 v[40:41], v56 offset:2048
    ds_read_b64_tr_b16 v[42:43], v56 offset:3072
    ds_read_b64_tr_b16 v[44:45], v57 offset:2048
    ds_read_b64_tr_b16 v[46:47], v57 offset:3072
    s_waitcnt lgkmcnt(2)
    v_mfma_f32_32x32x16_bf16 v[64:79], v[40:43], v[136:139], v[64:79]
    v_mfma_f32_32x32x16_bf16 v[80:95], v[40:43], v[140:143], v[80:95]
    s_waitcnt lgkmcnt(0)
    v_mfma_f32_32x32x16_bf16 v[96:111], v[44:47], v[136:139], v[96:111]
    v_mfma_f32_32x32x16_bf16 v[112:127], v[44:47], v[140:143], v[112:127]
    s_add_u32 m0, s64, 2048
    s_nop 0
    buffer_load_dwordx4 v58, s[44:47], s66 offen lds
    s_add_u32 m0, s64, 3072
    s_nop 0
    buffer_load_dwordx4 v59, s[44:47], s66 offen lds
    buffer_load_dwordx4 v[136:139], v2, s[24:27], s67 offen sc1
    buffer_load_dwordx4 v[140:143], v2, s[24:27], s68 offen sc1
    s_add_u32 s66, s66, 16384
    s_add_u32 s67, s67, 1024
    s_add_u32 s68, s68, 1024
    s_waitcnt vmcnt(24)
    ds_read_b64_tr_b16 v[40:41], v56 offset:4096
    ds_read_b64_tr_b16 v[42:43], v56 offset:5120
    ds_read_b64_tr_b16 v[44:45], v57 offset:4096
    ds_read_b64_tr_b16 v[46:47], v57 offset:5120
    s_waitcnt lgkmcnt(2)
    v_mfma_f32_32x32x16_bf16 v[64:79], v[40:43], v[144:147], v[64:79]
    v_mfma_f32_32x32x16_bf16 v[80:95], v[40:43], v[148:151], v[80:95]
    s_waitcnt lgkmcnt(0)
    v_mfma_f32_32x32x16_bf16 v[96:111], v[44:47], v[144:147], v[96:111]
    v_mfma_f32_32x32x16_bf16 v[112:127], v[44:47], v[148:151], v[112:127]
    s_add_u32 m0, s64, 4096
    s_nop 0
    buffer_load_dwordx4 v58, s[44:47], s66 offen lds
    s_add_u32 m0, s64, 5120
    s_nop 0
    buffer_load_dwordx4 v59, s[44:47], s66 offen lds
    buffer_load_dwordx4 v[144:147], v2, s[24:27], s67 offen sc1
    buffer_load_dwordx4 v[148:151], v2, s[24:27], s68 offen sc1
    s_add_u32 s66, s66, 16384
    s_add_u32 s67, s67, 1024
    s_add_u32 s68, s68, 1024
    s_waitcnt vmcnt(24)
    ds_read_b64_tr_b16 v[40:41], v56 offset:6144
    ds_read_b64_tr_b16 v[42:43], v56 offset:7168
    ds_read_b64_tr_b16 v[44:45], v57 offset:6144
    ds_read_b64_tr_b16 v[46:47], v57 offset:7168
    s_waitcnt lgkmcnt(2)
    v_mfma_f32_32x32x16_bf16 v[64:79], v[40:43], v[152:155], v[64:79]
    v_mfma_f32_32x32x16_bf16 v[80:95], v[40:43], v[156:159], v[80:95]
    s_waitcnt lgkmcnt(0)
    v_mfma_f32_32x32x16_bf16 v[96:111], v[44:47], v[152:155], v[96:111]
    v_mfma_f32_32x32x16_bf16 v[112:127], v[44:47], v[156:159], v[112:127]
    s_add_u32 m0, s64, 6144
    s_nop 0
    buffer_load_dwordx4 v58, s[44:47], s66 offen lds
    s_add_u32 m0, s64, 7168
    s_nop 0
    buffer_load_dwordx4 v59, s[44:47], s66 offen lds
    buffer_load_dwordx4 v[152:155], v2, s[24:27], s67 offen sc1
    buffer_load_dwordx4 v[156:159], v2, s[24:27], s68 offen sc1
    s_add_u32 s66, s66, 16384
    s_add_u32 s67, s67, 1024
    s_add_u32 s68, s68, 1024
    s_waitcnt vmcnt(24)
    ds_read_b64_tr_b16 v[40:41], v54 offset:0
    ds_read_b64_tr_b16 v[42:43], v54 offset:1024
    ds_read_b64_tr_b16 v[44:45], v55 offset:0
    ds_read_b64_tr_b16 v[46:47], v55 offset:1024
    s_waitcnt lgkmcnt(2)
    v_mfma_f32_32x32x16_bf16 v[64:79], v[40:43], v[160:163], v[64:79]
    v_mfma_f32_32x32x16_bf16 v[80:95], v[40:43], v[164:167], v[80:95]
    s_waitcnt lgkmcnt(0)
    v_mfma_f32_32x32x16_bf16 v[96:111], v[44:47], v[160:163], v[96:111]
    v_mfma_f32_32x32x16_bf16 v[112:127], v[44:47], v[164:167], v[112:127]
    s_add_u32 m0, s64, 4294836224
    s_nop 0
    buffer_load_dwordx4 v58, s[44:47], s66 offen lds
    s_add_u32 m0, s64, 4294837248
    s_nop 0
    buffer_load_dwordx4 v59, s[44:47], s66 offen lds
    buffer_load_dwordx4 v[160:163], v2, s[24:27], s67 offen sc1
    buffer_load_dwordx4 v[164:167], v2, s[24:27], s68 offen sc1
    s_add_u32 s66, s66, 16384
    s_add_u32 s67, s67, 1024
    s_add_u32 s68, s68, 1024
    s_waitcnt vmcnt(24)
    ds_read_b64_tr_b16 v[40:41], v54 offset:2048
    ds_read_b64_tr_b16 v[42:43], v54 offset:3072
    ds_read_b64_tr_b16 v[44:45], v55 offset:2048
    ds_read_b64_tr_b16 v[46:47], v55 offset:3072
    s_waitcnt lgkmcnt(2)
    v_mfma_f32_32x32x16_bf16 v[64:79], v[40:43], v[168:171], v[64:79]
    v_mfma_f32_32x32x16_bf16 v[80:95], v[40:43], v[172:175], v[80:95]
    s_waitcnt lgkmcnt(0)
    v_mfma_f32_32x32x16_bf16 v[96:111], v[44:47], v[168:171], v[96:111]
    v_mfma_f32_32x32x16_bf16 v[112:127], v[44:47], v[172:175], v[112:127]
    s_add_u32 m0, s64, 4294838272
    s_nop 0
    buffer_load_dwordx4 v58, s[44:47], s66 offen lds
    s_add_u32 m0, s64, 4294839296
    s_nop 0
    buffer_load_dwordx4 v59, s[44:47], s66 offen lds
    buffer_load_dwordx4 v[168:171], v2, s[24:27], s67 offen sc1
    buffer_load_dwordx4 v[172:175], v2, s[24:27], s68 offen sc1
    s_add_u32 s66, s66, 16384
    s_add_u32 s67, s67, 1024
    s_add_u32 s68, s68, 1024
    s_waitcnt vmcnt(24)
    ds_read_b64_tr_b16 v[40:41], v54 offset:4096
    ds_read_b64_tr_b16 v[42:43], v54 offset:5120
    ds_read_b64_tr_b16 v[44:45], v55 offset:4096
    ds_read_b64_tr_b16 v[46:47], v55 offset:5120
    s_waitcnt lgkmcnt(2)
    v_mfma_f32_32x32x16_bf16 v[64:79], v[40:43], v[176:179], v[64:79]
    v_mfma_f32_32x32x16_bf16 v[80:95], v[40:43], v[180:183], v[80:95]
    s_waitcnt lgkmcnt(0)
    v_mfma_f32_32x32x16_bf16 v[96:111], v[44:47], v[176:179], v[96:111]
    v_mfma_f32_32x32x16_bf16 v[112:127], v[44:47], v[180:183], v[112:127]
    s_add_u32 m0, s64, 4294840320
    s_nop 0
    buffer_load_dwordx4 v58, s[44:47], s66 offen lds
    s_add_u32 m0, s64, 4294841344
    s_nop 0
    buffer_load_dwordx4 v59, s[44:47], s66 offen lds
    buffer_load_dwordx4 v[176:179], v2, s[24:27], s67 offen sc1
    buffer_load_dwordx4 v[180:183], v2, s[24:27], s68 offen sc1
    s_add_u32 s66, s66, 16384
    s_add_u32 s67, s67, 1024
    s_add_u32 s68, s68, 1024
    s_sub_u32 s77, s77, 1
    s_cmp_lg_u32 s77, 0
    s_cbranch_scc1 M_gloop
    s_waitcnt vmcnt(24)
    ds_read_b64_tr_b16 v[40:41], v56 offset:0
    ds_read_b64_tr_b16 v[42:43], v56 offset:1024
    ds_read_b64_tr_b16 v[44:45], v57 offset:0
    ds_read_b64_tr_b16 v[46:47], v57 offset:1024
    s_waitcnt lgkmcnt(2)
    v_mfma_f32_32x32x16_bf16 v[64:79], v[40:43], v[128:131], v[64:79]
    v_mfma_f32_32x32x16_bf16 v[80:95], v[40:43], v[132:135], v[80:95]
    s_waitcnt lgkmcnt(0)
    v_mfma_f32_32x32x16_bf16 v[96:111], v[44:47], v[128:131], v[96:111]
    v_mfma_f32_32x32x16_bf16 v[112:127], v[44:47], v[132:135], v[112:127]
    s_waitcnt vmcnt(20)
    ds_read_b64_tr_b16 v[40:41], v56 offset:2048
    ds_read_b64_tr_b16 v[42:43], v56 offset:3072
    ds_read_b64_tr_b16 v[44:45], v57 offset:2048
    ds_read_b64_tr_b16 v[46:47], v57 offset:3072
    s_waitcnt lgkmcnt(2)
    v_mfma_f32_32x32x16_bf16 v[64:79], v[40:43], v[136:139], v[64:79]
    v_mfma_f32_32x32x16_bf16 v[80:95], v[40:43], v[140:143], v[80:95]
    s_waitcnt lgkmcnt(0)
    v_mfma_f32_32x32x16_bf16 v[96:111], v[44:47], v[136:139], v[96:111]
    v_mfma_f32_32x32x16_bf16 v[112:127], v[44:47], v[140:143], v[112:127]
    s_waitcnt vmcnt(16)
    ds_read_b64_tr_b16 v[40:41], v56 offset:4096
    ds_read_b64_tr_b16 v[42:43], v56 offset:5120
    ds_read_b64_tr_b16 v[44:45], v57 offset:4096
    ds_read_b64_tr_b16 v[46:47], v57 offset:5120
    s_waitcnt lgkmcnt(2)
    v_mfma_f32_32x32x16_bf16 v[64:79], v[40:43], v[144:147], v[64:79]
    v_mfma_f32_32x32x16_bf16 v[80:95], v[40:43], v[148:151], v[80:95]
    s_waitcnt lgkmcnt(0)
    v_mfma_f32_32x32x16_bf16 v[96:111], v[44:47], v[144:147], v[96:111]
    v_mfma_f32_32x32x16_bf16 v[112:127], v[44:47], v[148:151], v[112:127]
    s_waitcnt vmcnt(12)
    ds_read_b64_tr_b16 v[40:41], v56 offset:6144
    ds_read_b64_tr_b16 v[42:43], v56 offset:7168
    ds_read_b64_tr_b16 v[44:45], v57 offset:6144
    ds_read_b64_tr_b16 v[46:47], v57 offset:7168
    s_waitcnt lgkmcnt(2)
    v_mfma_f32_32x32x16_bf16 v[64:79], v[40:43], v[152:155], v[64:79]
    v_mfma_f32_32x32x16_bf16 v[80:95], v[40:43], v[156:159], v[80:95]
    s_waitcnt lgkmcnt(0)
    v_mfma_f32_32x32x16_bf16 v[96:111], v[44:47], v[152:155], v[96:111]
    v_mfma_f32_32x32x16_bf16 v[112:127], v[44:47], v[156:159], v[112:127]
    s_waitcnt vmcnt(8)
    ds_read_b64_tr_b16 v[40:41], v54 offset:0
    ds_read_b64_tr_b16 v[42:43], v54 offset:1024
    ds_read_b64_tr_b16 v[44:45], v55 offset:0
    ds_read_b64_tr_b16 v[46:47], v55 offset:1024
    s_waitcnt lgkmcnt(2)
    v_mfma_f32_32x32x16_bf16 v[64:79], v[40:43], v[160:163], v[64:79]
    v_mfma_f32_32x32x16_bf16 v[80:95], v[40:43], v[164:167], v[80:95]
    s_waitcnt lgkmcnt(0)
    v_mfma_f32_32x32x16_bf16 v[96:111], v[44:47], v[160:163], v[96:111]
    v_mfma_f32_32x32x16_bf16 v[112:127], v[44:47], v[164:167], v[112:127]
    s_waitcnt vmcnt(4)
    ds_read_b64_tr_b16 v[40:41], v54 offset:2048
    ds_read_b64_tr_b16 v[42:43], v54 offset:3072
    ds_read_b64_tr_b16 v[44:45], v55 offset:2048
    ds_read_b64_tr_b16 v[46:47], v55 offset:3072
    s_waitcnt lgkmcnt(2)
    v_mfma_f32_32x32x16_bf16 v[64:79], v[40:43], v[168:171], v[64:79]
    v_mfma_f32_32x32x16_bf16 v[80:95], v[40:43], v[172:175], v[80:95]
    s_waitcnt lgkmcnt(0)
    v_mfma_f32_32x32x16_bf16 v[96:111], v[44:47], v[168:171], v[96:111]
    v_mfma_f32_32x32x16_bf16 v[112:127], v[44:47], v[172:175], v[112:127]
    s_waitcnt vmcnt(0)
    ds_read_b64_tr_b16 v[40:41], v54 offset:4096
    ds_read_b64_tr_b16 v[42:43], v54 offset:5120
    ds_read_b64_tr_b16 v[44:45], v55 offset:4096
    ds_read_b64_tr_b16 v[46:47], v55 offset:5120
    s_waitcnt lgkmcnt(2)
    v_mfma_f32_32x32x16_bf16 v[64:79], v[40:43], v[176:179], v[64:79]
    v_mfma_f32_32x32x16_bf16 v[80:95], v[40:43], v[180:183], v[80:95]
    s_waitcnt lgkmcnt(0)
    v_mfma_f32_32x32x16_bf16 v[96:111], v[44:47], v[176:179], v[96:111]
    v_mfma_f32_32x32x16_bf16 v[112:127], v[44:47], v[180:183], v[112:127]
M_gskip:
    s_lshl_b32 s72, s33, 16
    s_add_u32 s72, s72, s65
    s_lshl_b32 s3, s37, 15
    s_add_u32 s72, s72, s3
    s_lshl_b32 s3, s36, 6
    s_add_u32 s72, s72, s3
    buffer_load_dwordx4 v[8:11], v212, s[40:43], s72 offen
    buffer_load_dwordx4 v[12:15], v212, s[40:43], s72 offen offset:32
    v_lshrrev_b32 v16, 8, v212
    s_lshr_b32 s3, s33, 1
    s_lshl_b32 s3, s3, 2
    s_and_b32 s71, s33, 1
    s_add_u32 s3, s3, s71
    s_lshl_b32 s3, s3, 1
    s_add_u32 s3, s3, s37
    s_lshl_b32 s3, s3, 7
    s_add_u32 s3, s3, 16220160
    buffer_load_dword v16, v16, s[24:27], s3 offen sc1
    s_nop 7
    ds_write_b128 v192, v[64:67]
    ds_write_b128 v193, v[68:71]
    ds_write_b128 v194, v[72:75]
    ds_write_b128 v195, v[76:79]
    ds_write_b128 v196, v[96:99]
    ds_write_b128 v197, v[100:103]
    ds_write_b128 v198, v[104:107]
    ds_write_b128 v199, v[108:111]
    ds_write_b128 v200, v[80:83]
    ds_write_b128 v201, v[84:87]
    ds_write_b128 v202, v[88:91]
    ds_write_b128 v203, v[92:95]
    ds_write_b128 v204, v[112:115]
    ds_write_b128 v205, v[116:119]
    ds_write_b128 v206, v[120:123]
    ds_write_b128 v207, v[124:127]
    s_mul_i32 s71, s33, 12288
    s_add_u32 s71, s71, 16253056
    s_cmp_lg_u32 s28, 0
    s_cbranch_scc1 M_pp_ok
    s_mov_b32 s3, 200000
M_pp:
    buffer_load_dword v5, v3, s[24:27], s71 offen sc1
    s_waitcnt vmcnt(0)
    v_cmp_ne_u32 vcc, s35, v5
    s_cbranch_vccz M_pp_ok
    s_sleep 2
    s_sub_u32 s3, s3, 1
    s_cmp_lg_u32 s3, 0
    s_cbranch_scc1 M_pp
M_pp_ok:
    s_waitcnt lgkmcnt(0)
    s_barrier
    ds_read_b128 v[128:131], v208 offset:0
    ds_read_b128 v[132:135], v209 offset:0
    ds_read_b128 v[136:139], v208 offset:8192
    ds_read_b128 v[140:143], v209 offset:8192
    ds_read_b128 v[144:147], v208 offset:16384
    ds_read_b128 v[148:151], v209 offset:16384
    ds_read_b128 v[152:155], v208 offset:24576
    ds_read_b128 v[156:159], v209 offset:24576
    ds_read_b128 v[160:163], v210 offset:0
    ds_read_b128 v[164:167], v211 offset:0
    ds_read_b128 v[168:171], v210 offset:8192
    ds_read_b128 v[172:175], v211 offset:8192
    ds_read_b128 v[176:179], v210 offset:16384
    ds_read_b128 v[180:183], v211 offset:16384
    ds_read_b128 v[184:187], v210 offset:24576
    ds_read_b128 v[188:191], v211 offset:24576
    s_lshl_b32 s71, s28, 10
    s_add_u32 s71, s71, 0x8000
    s_lshl_b32 s73, s28, 13
    s_mov_b32 s3, 16
M_wol:
    s_mov_b32 m0, s71
    s_add_u32 s71, s71, 4096
    buffer_load_dwordx4 v58, s[48:51], s73 offen lds
    s_add_u32 s73, s73, 32768
    s_sub_u32 s3, s3, 1
    s_cmp_lg_u32 s3, 0
    s_cbranch_scc1 M_wol
    s_mov_b32 s3, 0xbfb8aa3b
    v_and_b32 v4, 7, v255
    v_lshlrev_b32 v4, 2, v4
    v_add_u32 v4, 102912, v4
    v_mov_b32 v5, 0
    ds_write_b32 v4, v5
    s_waitcnt vmcnt(0) lgkmcnt(0)
    s_barrier
    v_add_f32 v128, v128, v136
    v_add_f32 v129, v129, v137
    v_add_f32 v130, v130, v138
    v_add_f32 v131, v131, v139
    v_add_f32 v132, v132, v140
    v_add_f32 v133, v133, v141
    v_add_f32 v134, v134, v142
    v_add_f32 v135, v135, v143
    v_add_f32 v144, v144, v152
    v_add_f32 v145, v145, v153
    v_add_f32 v146, v146, v154
    v_add_f32 v147, v147, v155
    v_add_f32 v148, v148, v156
    v_add_f32 v149, v149, v157
    v_add_f32 v150, v150, v158
    v_add_f32 v151, v151, v159
    v_mul_f32 v16, v16, v16
    v_add_f32 v128, v128, v144
    v_add_f32 v129, v129, v145
    v_add_f32 v130, v130, v146
    v_add_f32 v131, v131, v147
    v_add_f32 v132, v132, v148
    v_add_f32 v133, v133, v149
    v_add_f32 v134, v134, v150
    v_add_f32 v135, v135, v151
    v_mul_f32 v128, v128, v16
    v_mul_f32 v129, v129, v16
    v_mul_f32 v130, v130, v16
    v_mul_f32 v131, v131, v16
    v_mul_f32 v132, v132, v16
    v_mul_f32 v133, v133, v16
    v_mul_f32 v134, v134, v16
    v_mul_f32 v135, v135, v16
    v_cvt_pk_bf16_f32 v136, v128, v129
    v_cvt_pk_bf16_f32 v137, v130, v131
    v_cvt_pk_bf16_f32 v138, v132, v133
    v_cvt_pk_bf16_f32 v139, v134, v135
    v_lshlrev_b32 v128, 16, v136
    v_and_b32 v129, 0xffff0000, v136
    v_lshlrev_b32 v130, 16, v137
    v_and_b32 v131, 0xffff0000, v137
    v_lshlrev_b32 v132, 16, v138
    v_and_b32 v133, 0xffff0000, v138
    v_lshlrev_b32 v134, 16, v139
    v_and_b32 v135, 0xffff0000, v139
    v_add_f32 v160, v160, v168
    v_add_f32 v161, v161, v169
    v_add_f32 v162, v162, v170
    v_add_f32 v163, v163, v171
    v_add_f32 v164, v164, v172
    v_add_f32 v165, v165, v173
    v_add_f32 v166, v166, v174
    v_add_f32 v167, v167, v175
    v_add_f32 v176, v176, v184
    v_add_f32 v177, v177, v185
    v_add_f32 v178, v178, v186
    v_add_f32 v179, v179, v187
    v_add_f32 v180, v180, v188
    v_add_f32 v181, v181, v189
    v_add_f32 v182, v182, v190
    v_add_f32 v183, v183, v191
    v_add_f32 v160, v160, v176
    v_add_f32 v161, v161, v177
    v_add_f32 v162, v162, v178
    v_add_f32 v163, v163, v179
    v_add_f32 v164, v164, v180
    v_add_f32 v165, v165, v181
    v_add_f32 v166, v166, v182
    v_add_f32 v167, v167, v183
    v_mul_f32 v160, v160, v16
    v_mul_f32 v161, v161, v16
    v_mul_f32 v162, v162, v16
    v_mul_f32 v163, v163, v16
    v_mul_f32 v164, v164, v16
    v_mul_f32 v165, v165, v16
    v_mul_f32 v166, v166, v16
    v_mul_f32 v167, v167, v16
    v_cvt_pk_bf16_f32 v168, v160, v161
    v_cvt_pk_bf16_f32 v169, v162, v163
    v_cvt_pk_bf16_f32 v170, v164, v165
    v_cvt_pk_bf16_f32 v171, v166, v167
    v_lshlrev_b32 v160, 16, v168
    v_and_b32 v161, 0xffff0000, v168
    v_lshlrev_b32 v162, 16, v169
    v_and_b32 v163, 0xffff0000, v169
    v_lshlrev_b32 v164, 16, v170
    v_and_b32 v165, 0xffff0000, v170
    v_lshlrev_b32 v166, 16, v171
    v_and_b32 v167, 0xffff0000, v171
    v_mul_f32 v144, s3, v128
    v_mul_f32 v145, s3, v129
    v_mul_f32 v146, s3, v130
    v_mul_f32 v147, s3, v131
    v_mul_f32 v148, s3, v132
    v_mul_f32 v149, s3, v133
    v_mul_f32 v150, s3, v134
    v_mul_f32 v151, s3, v135
    v_exp_f32 v144, v144
    v_exp_f32 v145, v145
    v_exp_f32 v146, v146
    v_exp_f32 v147, v147
    v_exp_f32 v148, v148
    v_exp_f32 v149, v149
    v_exp_f32 v150, v150
    v_exp_f32 v151, v151
    v_add_f32 v144, 1.0, v144
    v_add_f32 v145, 1.0, v145
    v_add_f32 v146, 1.0, v146
    v_add_f32 v147, 1.0, v147
    v_add_f32 v148, 1.0, v148
    v_add_f32 v149, 1.0, v149
    v_add_f32 v150, 1.0, v150
    v_add_f32 v151, 1.0, v151
    v_rcp_f32 v144, v144
    v_rcp_f32 v145, v145
    v_rcp_f32 v146, v146
    v_rcp_f32 v147, v147
    v_rcp_f32 v148, v148
    v_rcp_f32 v149, v149
    v_rcp_f32 v150, v150
    v_rcp_f32 v151, v151
    v_mul_f32 v128, v128, v144
    v_mul_f32 v129, v129, v145
    v_mul_f32 v130, v130, v146
    v_mul_f32 v131, v131, v147
    v_mul_f32 v132, v132, v148
    v_mul_f32 v133, v133, v149
    v_mul_f32 v134, v134, v150
    v_mul_f32 v135, v135, v151
    v_cvt_pk_bf16_f32 v136, v128, v129
    v_cvt_pk_bf16_f32 v137, v130, v131
    v_cvt_pk_bf16_f32 v138, v132, v133
    v_cvt_pk_bf16_f32 v139, v134, v135
    v_lshlrev_b32 v96, 16, v136
    v_and_b32 v97, 0xffff0000, v136
    v_lshlrev_b32 v104, 16, v8
    v_and_b32 v105, 0xffff0000, v8
    v_lshlrev_b32 v98, 16, v137
    v_and_b32 v99, 0xffff0000, v137
    v_lshlrev_b32 v106, 16, v9
    v_and_b32 v107, 0xffff0000, v9
    v_lshlrev_b32 v100, 16, v138
    v_and_b32 v101, 0xffff0000, v138
    v_lshlrev_b32 v108, 16, v10
    v_and_b32 v109, 0xffff0000, v10
    v_lshlrev_b32 v102, 16, v139
    v_and_b32 v103, 0xffff0000, v139
    v_lshlrev_b32 v110, 16, v11
    v_and_b32 v111, 0xffff0000, v11
    v_mul_f32 v176, s3, v160
    v_mul_f32 v177, s3, v161
    v_mul_f32 v178, s3, v162
    v_mul_f32 v179, s3, v163
    v_mul_f32 v180, s3, v164
    v_mul_f32 v181, s3, v165
    v_mul_f32 v182, s3, v166
    v_mul_f32 v183, s3, v167
    v_exp_f32 v176, v176
    v_exp_f32 v177, v177
    v_exp_f32 v178, v178
    v_exp_f32 v179, v179
    v_exp_f32 v180, v180
    v_exp_f32 v181, v181
    v_exp_f32 v182, v182
    v_exp_f32 v183, v183
    v_add_f32 v176, 1.0, v176
    v_add_f32 v177, 1.0, v177
    v_add_f32 v178, 1.0, v178
    v_add_f32 v179, 1.0, v179
    v_add_f32 v180, 1.0, v180
    v_add_f32 v181, 1.0, v181
    v_add_f32 v182, 1.0, v182
    v_add_f32 v183, 1.0, v183
    v_rcp_f32 v176, v176
    v_rcp_f32 v177, v177
    v_rcp_f32 v178, v178
    v_rcp_f32 v179, v179
    v_rcp_f32 v180, v180
    v_rcp_f32 v181, v181
    v_rcp_f32 v182, v182
    v_rcp_f32 v183, v183
    v_mul_f32 v160, v160, v176
    v_mul_f32 v161, v161, v177
    v_mul_f32 v162, v162, v178
    v_mul_f32 v163, v163, v179
    v_mul_f32 v164, v164, v180
    v_mul_f32 v165, v165, v181
    v_mul_f32 v166, v166, v182
    v_mul_f32 v167, v167, v183
    v_cvt_pk_bf16_f32 v168, v160, v161
    v_cvt_pk_bf16_f32 v169, v162, v163
    v_cvt_pk_bf16_f32 v170, v164, v165
    v_cvt_pk_bf16_f32 v171, v166, v167
    v_lshlrev_b32 v112, 16, v168
    v_and_b32 v113, 0xffff0000, v168
    v_lshlrev_b32 v120, 16, v12
    v_and_b32 v121, 0xffff0000, v12
    v_lshlrev_b32 v114, 16, v169
    v_and_b32 v115, 0xffff0000, v169
    v_lshlrev_b32 v122, 16, v13
    v_and_b32 v123, 0xffff0000, v13
    v_lshlrev_b32 v116, 16, v170
    v_and_b32 v117, 0xffff0000, v170
    v_lshlrev_b32 v124, 16, v14
    v_and_b32 v125, 0xffff0000, v14
    v_lshlrev_b32 v118, 16, v171
    v_and_b32 v119, 0xffff0000, v171
    v_lshlrev_b32 v126, 16, v15
    v_and_b32 v127, 0xffff0000, v15
    s_mov_b32 s77, 0xff
    s_mov_b32 s76, 1600000
M_p4w:
    ds_read_b32 v5, v4
    s_sub_u32 s76, s76, 1
    s_cbranch_scc1 M_p4x
    s_waitcnt lgkmcnt(0)
    v_cmp_eq_u32 vcc, s35, v5
    s_nop 0
    s_and_b32 s75, vcc_lo, s77
    s_cbranch_scc0 M_p4w
    s_ff1_i32_b32 s3, s75
    s_bitset0_b32 s75, s3
    s_bitset0_b32 s77, s3
    s_lshl_b32 s74, s3, 13
    v_add_u32 v56, s74, v214
    s_lshl_b32 s74, s3, 12
    v_add_u32 v57, s74, v215
    ds_read_b64_tr_b16 v[24:25], v56 offset:0
    ds_read_b64_tr_b16 v[26:27], v56 offset:1024
    ds_read_b128 v[40:43], v57 offset:0
    ds_read_b64_tr_b16 v[28:29], v56 offset:2048
    ds_read_b64_tr_b16 v[30:31], v56 offset:3072
    ds_read_b128 v[44:47], v57 offset:1024
    ds_read_b64_tr_b16 v[32:33], v56 offset:4096
    ds_read_b64_tr_b16 v[34:35], v56 offset:5120
    ds_read_b128 v[48:51], v57 offset:2048
    ds_read_b64_tr_b16 v[36:37], v56 offset:6144
    ds_read_b64_tr_b16 v[38:39], v56 offset:7168
    ds_read_b128 v[52:55], v57 offset:3072
    ds_read_b32 v5, v4
M_p40:
    s_waitcnt lgkmcnt(10)
    v_mfma_f32_32x32x16_bf16 v[216:231], v[24:27], v[40:43], v[216:231]
    s_waitcnt lgkmcnt(0)
    v_cmp_eq_u32 vcc, s35, v5
    v_mfma_f32_32x32x16_bf16 v[216:231], v[28:31], v[44:47], v[216:231]
    s_and_b32 s75, vcc_lo, s77
    s_cbranch_scc0 M_p4e0
    s_ff1_i32_b32 s3, s75
    s_bitset0_b32 s75, s3
    s_bitset0_b32 s77, s3
    s_lshl_b32 s74, s3, 13
    v_add_u32 v56, s74, v214
    s_lshl_b32 s74, s3, 12
    v_add_u32 v57, s74, v215
    ds_read_b64_tr_b16 v[64:65], v56 offset:0
    ds_read_b64_tr_b16 v[66:67], v56 offset:1024
    ds_read_b128 v[80:83], v57 offset:0
    v_mfma_f32_32x32x16_bf16 v[216:231], v[32:35], v[48:51], v[216:231]
    ds_read_b64_tr_b16 v[68:69], v56 offset:2048
    ds_read_b64_tr_b16 v[70:71], v56 offset:3072
    ds_read_b128 v[84:87], v57 offset:1024
    ds_read_b64_tr_b16 v[72:73], v56 offset:4096
    ds_read_b64_tr_b16 v[74:75], v56 offset:5120
    ds_read_b128 v[88:91], v57 offset:2048
    ds_read_b64_tr_b16 v[76:77], v56 offset:6144
    v_mfma_f32_32x32x16_bf16 v[216:231], v[36:39], v[52:55], v[216:231]
    ds_read_b64_tr_b16 v[78:79], v56 offset:7168
    ds_read_b128 v[92:95], v57 offset:3072
    ds_read_b32 v5, v4
M_p41:
    s_waitcnt lgkmcnt(10)
    v_mfma_f32_32x32x16_bf16 v[216:231], v[64:67], v[80:83], v[216:231]
    s_waitcnt lgkmcnt(0)
    v_cmp_eq_u32 vcc, s35, v5
    v_mfma_f32_32x32x16_bf16 v[216:231], v[68:71], v[84:87], v[216:231]
    s_and_b32 s75, vcc_lo, s77
    s_cbranch_scc0 M_p4e1
    s_ff1_i32_b32 s3, s75
    s_bitset0_b32 s75, s3
    s_bitset0_b32 s77, s3
    s_lshl_b32 s74, s3, 13
    v_add_u32 v56, s74, v214
    s_lshl_b32 s74, s3, 12
    v_add_u32 v57, s74, v215
    ds_read_b64_tr_b16 v[24:25], v56 offset:0
    ds_read_b64_tr_b16 v[26:27], v56 offset:1024
    ds_read_b128 v[40:43], v57 offset:0
    v_mfma_f32_32x32x16_bf16 v[216:231], v[72:75], v[88:91], v[216:231]
    ds_read_b64_tr_b16 v[28:29], v56 offset:2048
    ds_read_b64_tr_b16 v[30:31], v56 offset:3072
    ds_read_b128 v[44:47], v57 offset:1024
    ds_read_b64_tr_b16 v[32:33], v56 offset:4096
    ds_read_b64_tr_b16 v[34:35], v56 offset:5120
    ds_read_b128 v[48:51], v57 offset:2048
    ds_read_b64_tr_b16 v[36:37], v56 offset:6144
    v_mfma_f32_32x32x16_bf16 v[216:231], v[76:79], v[92:95], v[216:231]
    ds_read_b64_tr_b16 v[38:39], v56 offset:7168
    ds_read_b128 v[52:55], v57 offset:3072
    ds_read_b32 v5, v4
    s_branch M_p40
M_p4e0:
    v_mfma_f32_32x32x16_bf16 v[216:231], v[32:35], v[48:51], v[216:231]
    v_mfma_f32_32x32x16_bf16 v[216:231], v[36:39], v[52:55], v[216:231]
    s_cmp_lg_u32 s77, 0
    s_cbranch_scc1 M_p4w
    s_branch M_p4x
M_p4e1:
    v_mfma_f32_32x32x16_bf16 v[216:231], v[72:75], v[88:91], v[216:231]
    v_mfma_f32_32x32x16_bf16 v[216:231], v[76:79], v[92:95], v[216:231]
    s_cmp_lg_u32 s77, 0
    s_cbranch_scc1 M_p4w
M_p4x:
    s_mov_b32 s76, 8
M_p4c:
    s_nop 9
    v_cmp_u_f32 vcc, v216, v231
    s_cbranch_vccnz M_redo
M_p4ok:
    v_cvt_pk_bf16_f32 v24, v216, v217
    v_cvt_pk_bf16_f32 v25, v218, v219
    v_cvt_pk_bf16_f32 v26, v220, v221
    v_cvt_pk_bf16_f32 v27, v222, v223
    v_cvt_pk_bf16_f32 v28, v224, v225
    v_cvt_pk_bf16_f32 v29, v226, v227
    v_cvt_pk_bf16_f32 v30, v228, v229
    v_cvt_pk_bf16_f32 v31, v230, v231
    s_nop 1
    v_permlane32_swap_b32 v24, v26
    v_permlane32_swap_b32 v25, v27
    v_permlane32_swap_b32 v28, v30
    v_permlane32_swap_b32 v29, v31
    s_nop 1
    v_lshlrev_b32 v216, 16, v24
    v_and_b32 v217, 0xffff0000, v24
    v_lshlrev_b32 v218, 16, v25
    v_and_b32 v219, 0xffff0000, v25
    v_lshlrev_b32 v220, 16, v26
    v_and_b32 v221, 0xffff0000, v26
    v_lshlrev_b32 v222, 16, v27
    v_and_b32 v223, 0xffff0000, v27
    v_pk_fma_f32 v[216:217], v[216:217], v[96:97], v[104:105]
    v_pk_fma_f32 v[218:219], v[218:219], v[98:99], v[106:107]
    v_pk_fma_f32 v[220:221], v[220:221], v[100:101], v[108:109]
    v_pk_fma_f32 v[222:223], v[222:223], v[102:103], v[110:111]
    v_cvt_pk_bf16_f32 v24, v216, v217
    v_cvt_pk_bf16_f32 v25, v218, v219
    v_cvt_pk_bf16_f32 v26, v220, v221
    v_cvt_pk_bf16_f32 v27, v222, v223
    buffer_store_dwordx4 v[24:27], v212, s[52:55], s72 offen offset:0
    v_lshlrev_b32 v224, 16, v28
    v_and_b32 v225, 0xffff0000, v28
    v_lshlrev_b32 v226, 16, v29
    v_and_b32 v227, 0xffff0000, v29
    v_lshlrev_b32 v228, 16, v30
    v_and_b32 v229, 0xffff0000, v30
    v_lshlrev_b32 v230, 16, v31
    v_and_b32 v231, 0xffff0000, v31
    v_pk_fma_f32 v[224:225], v[224:225], v[112:113], v[120:121]
    v_pk_fma_f32 v[226:227], v[226:227], v[114:115], v[122:123]
    v_pk_fma_f32 v[228:229], v[228:229], v[116:117], v[124:125]
    v_pk_fma_f32 v[230:231], v[230:231], v[118:119], v[126:127]
    v_cvt_pk_bf16_f32 v28, v224, v225
    v_cvt_pk_bf16_f32 v29, v226, v227
    v_cvt_pk_bf16_f32 v30, v228, v229
    v_cvt_pk_bf16_f32 v31, v230, v231
    buffer_store_dwordx4 v[28:31], v212, s[52:55], s72 offen offset:32
    s_endpgm
M_redo:
    s_sub_u32 s76, s76, 1
    s_cbranch_scc1 M_p4ok
    s_lshl1_add_u32 s74, s33, s37
    s_lshl_b32 s74, s74, 15
    s_add_u32 s74, s74, 13631488
    v_mov_b32 v56, v214
    s_mov_b32 s77, 32
    v_mov_b32 v216, 0
    v_mov_b32 v217, 0
    v_mov_b32 v218, 0
    v_mov_b32 v219, 0
    v_mov_b32 v220, 0
    v_mov_b32 v221, 0
    v_mov_b32 v222, 0
    v_mov_b32 v223, 0
    v_mov_b32 v224, 0
    v_mov_b32 v225, 0
    v_mov_b32 v226, 0
    v_mov_b32 v227, 0
    v_mov_b32 v228, 0
    v_mov_b32 v229, 0
    v_mov_b32 v230, 0
    v_mov_b32 v231, 0
M_redo1:
    buffer_load_dwordx4 v[40:43], v2, s[24:27], s74 offen sc1
    ds_read_b64_tr_b16 v[24:25], v56
    ds_read_b64_tr_b16 v[26:27], v56 offset:1024
    s_add_u32 s74, s74, 1024
    v_add_u32 v56, 2048, v56
    s_waitcnt vmcnt(0) lgkmcnt(0)
    v_mfma_f32_32x32x16_bf16 v[216:231], v[24:27], v[40:43], v[216:231]
    s_nop 7
    s_sub_u32 s77, s77, 1
    s_cmp_lg_u32 s77, 0
    s_cbranch_scc1 M_redo1
    s_branch M_p4c
M_C:
    v_mov_b64 v[248:249], 0
    s_nop 1
    v_mfma_f32_32x32x8_bf16 v[144:159], v[248:249], v[248:249], 0
    s_load_dwordx8 s[12:19], s[0:1], 32
    s_load_dwordx2 s[8:9], s[0:1], 16
    v_mfma_f32_32x32x8_bf16 v[128:143], v[248:249], v[248:249], 0
    s_load_dwordx4 s[20:23], s[0:1], 64
    s_and_b32 s29, s2, 7
    v_mfma_f32_32x32x8_bf16 v[112:127], v[248:249], v[248:249], 0
    s_lshl_b32 s33, s29, 2
    s_lshl_b32 s29, s100, 1
    v_mfma_f32_32x32x8_bf16 v[96:111], v[248:249], v[248:249], 0
    s_bfe_u32 s30, s2, 0x10006
    s_add_u32 s29, s29, s30
    v_mfma_f32_32x32x8_bf16 v[80:95], v[248:249], v[248:249], 0
    s_and_b32 s101, s31, 3
    s_bfe_u32 s3, s2, 0x20003
    v_mfma_f32_32x32x8_bf16 v[64:79], v[248:249], v[248:249], 0
    s_add_u32 s33, s33, s3
    s_lshr_b32 s34, s2, 5
    v_mfma_f32_32x32x8_bf16 v[48:63], v[248:249], v[248:249], 0
    s_mov_b32 s26, 17825792
    s_mov_b32 s27, 0x20000
    v_mfma_f32_32x32x8_bf16 v[32:47], v[248:249], v[248:249], 0
    s_and_b32 s36, s28, 1
    v_mfma_f32_32x32x8_bf16 v[16:31], v[248:249], v[248:249], 0
    s_lshr_b32 s37, s28, 1
    s_memrealtime s[56:57]
    s_mov_b32 s47, 0x20000
    s_mov_b32 s67, 0x20000
    v_lshrrev_b32 v2, 5, v255
    v_bfe_u32 v3, v255, 2, 2
    v_lshl_add_u32 v6, v2, 3, v3
    v_and_b32 v4, 3, v255
    v_lshlrev_b32 v4, 3, v4
    v_bfe_u32 v5, v255, 4, 1
    v_lshl_add_u32 v224, v6, 7, v4
    v_lshl_add_u32 v224, v5, 5, v224
    v_bfe_u32 v7, v255, 3, 1
    v_lshl_add_u32 v224, v7, 6, v224
    s_lshl_b32 s3, s37, 11
    s_lshl_b32 s53, s37, 6
    s_cmp_eq_u32 s30, 0
    s_cselect_b32 s3, s3, s53
    v_xor_b32 v224, s3, v224
    v_xor_b32 v225, 64, v224
    v_add_u32 v229, 151552, v224
    v_lshl_add_u32 v7, v6, 8, v4
    v_lshl_add_u32 v7, v5, 13, v7
    v_lshl_add_u32 v3, v5, 2, v3
    v_lshl_add_u32 v237, v3, 5, v7
    s_bfe_u32 s59, s29, 0x10001
    s_lshl_b32 s59, s59, 1
    s_mul_i32 s3, s37, 3
    s_add_u32 s59, s59, s3
    s_lshl_b32 s3, s37, 2
    s_cmp_eq_u32 s30, 1
    s_cselect_b32 s59, s3, s59
    v_and_b32 v3, 31, v255
    v_bfe_u32 v4, v255, 1, 3
    v_xor_b32 v4, v4, v2
    v_lshlrev_b32 v4, 4, v4
    v_lshl_add_u32 v3, v3, 7, v4
    s_lshl_b32 s3, s36, 13
    s_add_u32 s3, s3, 65536
    v_add_u32 v228, s3, v3
    v_mov_b32 v230, v228
    v_xor_b32 v231, 32, v228
    s_mov_b32 s40, 0x3f803f80
    s_mov_b32 s41, 0
    s_mov_b32 s42, 0
    s_mov_b32 s38, 4294901760
    s_mov_b32 s39, 4294918144
    s_mov_b32 s77, 8
    s_lshr_b32 s58, s101, 1
    s_waitcnt lgkmcnt(0)
    s_mov_b64 s[24:25], s[22:23]
    s_or_b32 s56, s56, 1
    v_mov_b32 v252, s56
    v_lshlrev_b32 v253, 2, v255
    s_or_b32 s3, s28, s2
    s_cmp_lg_u32 s3, 0
    s_cbranch_scc1 M_notag
    global_store_dword v253, v252, s[20:21] sc1
M_notag:
    s_lshl_b32 s68, s2, 1
    s_add_u32 s68, s68, s36
    s_lshl_b32 s68, s68, 12
    s_cmp_eq_u32 s37, 0
    s_cselect_b32 s64, s16, s8
    s_cselect_b32 s65, s17, s9
    s_mov_b32 s66, 524288
    s_cselect_b32 s66, 1835008, s66
    v_mfma_f32_32x32x8_bf16 v[0:15], v[248:249], v[248:249], 0
    v_mov_b32 v240, 0
    v_mov_b32 v241, 0
    v_mov_b32 v242, 0
    v_mov_b32 v243, 0
    v_mov_b32 v176, 0
    v_mov_b32 v177, 0
    v_mov_b32 v178, 0
    v_mov_b32 v179, 0
    s_mov_b32 s44, 989855744
    s_mov_b32 s45, 925353388
    s_waitcnt vmcnt(0)
    v_dot2c_f32_bf16 v176, s40, v160
    v_dot2c_f32_bf16 v178, v160, v160
    v_dot2c_f32_bf16 v177, s40, v164
    v_dot2c_f32_bf16 v179, v164, v164
    v_dot2c_f32_bf16 v176, s40, v161
    v_dot2c_f32_bf16 v178, v161, v161
    v_dot2c_f32_bf16 v177, s40, v165
    v_dot2c_f32_bf16 v179, v165, v165
    v_dot2c_f32_bf16 v176, s40, v162
    v_dot2c_f32_bf16 v178, v162, v162
    v_dot2c_f32_bf16 v177, s40, v166
    v_dot2c_f32_bf16 v179, v166, v166
    v_dot2c_f32_bf16 v176, s40, v163
    v_dot2c_f32_bf16 v178, v163, v163
    v_dot2c_f32_bf16 v177, s40, v167
    v_dot2c_f32_bf16 v179, v167, v167
    s_nop 2
    v_permlane32_swap_b32 v176, v177
    v_permlane32_swap_b32 v178, v179
    s_nop 1
    v_add_f32 v176, v176, v177
    v_add_f32 v178, v178, v179
    s_nop 1
    v_permlane16_swap_b32 v176, v178
    s_nop 1
    v_add_f32 v176, v176, v178
    s_nop 1
    v_add_f32_dpp v176, v176, v176 row_ror:8 row_mask:0xf bank_mask:0xf
    s_nop 1
    v_add_f32_dpp v176, v176, v176 row_ror:4 row_mask:0xf bank_mask:0xf
    s_nop 1
    v_add_f32_dpp v176, v176, v176 row_ror:2 row_mask:0xf bank_mask:0xf
    s_nop 1
    v_add_f32_dpp v176, v176, v176 row_ror:1 row_mask:0xf bank_mask:0xf
    v_mov_b32 v177, v176
    s_and_b32 s52, s52, 63
    s_lshl_b32 s52, s52, 3
    v_permlane16_swap_b32 v176, v177
    v_lshrrev_b32 v180, 5, v255
    v_lshlrev_b32 v180, 2, v180
    v_and_b32 v181, 1, v255
    v_lshl_add_u32 v180, v181, 9, v180
    v_cmp_eq_u32 vcc, 1, v181
    s_lshl_b32 s3, s31, 10
    s_add_u32 s52, s52, s3
    s_add_u32 s52, s52, 16220160
    v_mul_f32 v244, s44, v176
    v_mul_f32 v245, s44, v177
    v_fma_f32 v245, -v244, v244, v245
    v_cvt_pk_bf16_f32 v179, -v244, -v244
    v_max_f32 v245, 0, v245
    v_cvt_pk_bf16_f32 v245, v245, v245
    v_and_b32 v245, 0xffff0000, v245
    v_add_f32 v245, s45, v245
    v_cvt_pk_bf16_f32 v245, v245, v245
    v_and_b32 v245, 0xffff0000, v245
    v_sqrt_f32 v245, v245
    s_mov_b32 s56, 3
    v_cvt_pk_bf16_f32 v245, v245, v245
    v_and_b32 v245, 0xffff0000, v245
    v_rcp_f32 v178, v245
    s_mov_b32 s57, 3
    v_cndmask_b32 v178, v178, v179, vcc
    s_mov_b64 exec, s[56:57]
    buffer_store_dword v178, v180, s[24:27], s52 offen sc1
    s_mov_b64 exec, -1
    s_cmp_eq_u32 s37, 0
    s_cselect_b32 s44, s12, s14
    s_cselect_b32 s45, s13, s15
    s_mov_b32 s46, 1835008
    s_mov_b32 s57, 6
    s_add_u32 s52, s30, s37
    s_add_u32 s52, s52, s30
    s_barrier
    s_cmp_eq_u32 s52, 1
    s_cbranch_scc1 M_a1i
    s_cmp_gt_u32 s52, 1
    s_cbranch_scc1 M_a2i
M_a0i:
    ds_read_b128 v[160:163], v230
    ds_read_b64_tr_b16 v[192:193], v224 offset:0
    ds_read_b64_tr_b16 v[194:195], v224 offset:512
    ds_read_b128 v[164:167], v230 offset:4096
    ds_read_b64_tr_b16 v[196:197], v225 offset:0
    ds_read_b64_tr_b16 v[198:199], v225 offset:512
    ds_read_b128 v[168:171], v231
    ds_read_b64_tr_b16 v[200:201], v224 offset:4096
    ds_read_b64_tr_b16 v[202:203], v224 offset:4608
    ds_read_b128 v[172:175], v231 offset:4096
    ds_read_b64_tr_b16 v[204:205], v225 offset:4096
    ds_read_b64_tr_b16 v[206:207], v225 offset:4608
    v_xor_b32 v230, 64, v228
    v_xor_b32 v231, 0x60, v228
.p2align 3
M_a0:
    s_waitcnt lgkmcnt(0)
    v_mfma_f32_32x32x16_bf16 v[96:111], v[192:195], v[160:163], v[96:111]
    ds_read_b128 v[176:179], v230
    ds_read_b64_tr_b16 v[208:209], v224 offset:8192
    ds_read_b64_tr_b16 v[210:211], v224 offset:8704
    ds_read_b128 v[180:183], v230 offset:4096
    v_mfma_f32_32x32x16_bf16 v[112:127], v[192:195], v[164:167], v[112:127]
    ds_read_b64_tr_b16 v[212:213], v225 offset:8192
    ds_read_b64_tr_b16 v[214:215], v225 offset:8704
    ds_read_b128 v[184:187], v231
    ds_read_b64_tr_b16 v[216:217], v224 offset:12288
    v_mfma_f32_32x32x16_bf16 v[128:143], v[196:199], v[160:163], v[128:143]
    ds_read_b64_tr_b16 v[218:219], v224 offset:12800
    ds_read_b128 v[188:191], v231 offset:4096
    ds_read_b64_tr_b16 v[220:221], v225 offset:12288
    ds_read_b64_tr_b16 v[222:223], v225 offset:12800
    v_mfma_f32_32x32x16_bf16 v[144:159], v[196:199], v[164:167], v[144:159]
    s_add_u32 s42, s42, 16384
    s_cmp_eq_u32 s42, 65536
    s_cselect_b32 s43, s39, 16384
    s_cselect_b32 s42, 0, s42
    v_mfma_f32_32x32x16_bf16 v[96:111], v[200:203], v[168:171], v[96:111]
    v_add_u32 v224, s43, v224
    v_add_u32 v225, s43, v225
    s_add_u32 s41, s41, 16384
    s_cmp_eq_u32 s41, 81920
    v_mfma_f32_32x32x16_bf16 v[112:127], v[200:203], v[172:175], v[112:127]
    s_cselect_b32 s3, s38, 16384
    s_cselect_b32 s41, 0, s41
    v_add_u32 v228, s3, v228
    v_xor_b32 v230, 0, v228
    v_mfma_f32_32x32x16_bf16 v[128:143], v[204:207], v[168:171], v[128:143]
    v_xor_b32 v231, 32, v228
    s_cmp_eq_u32 s58, 0
    v_mfma_f32_32x32x16_bf16 v[144:159], v[204:207], v[172:175], v[144:159]
    s_cbranch_scc1 M_a0_d0
M_a0_r0:
    s_waitcnt lgkmcnt(0)
    v_mfma_f32_32x32x16_bf16 v[96:111], v[208:211], v[176:179], v[96:111]
    s_cmp_gt_u32 s77, 5
    s_cbranch_scc1 M_a0_nw
    s_waitcnt vmcnt(0)
M_a0_nw:
    s_barrier
    ds_read_b128 v[160:163], v230
    ds_read_b64_tr_b16 v[192:193], v224 offset:0
    v_mfma_f32_32x32x16_bf16 v[112:127], v[208:211], v[180:183], v[112:127]
    ds_read_b64_tr_b16 v[194:195], v224 offset:512
    ds_read_b128 v[164:167], v230 offset:4096
    ds_read_b64_tr_b16 v[196:197], v225 offset:0
    ds_read_b64_tr_b16 v[198:199], v225 offset:512
    v_mfma_f32_32x32x16_bf16 v[128:143], v[212:215], v[176:179], v[128:143]
    ds_read_b128 v[168:171], v231
    ds_read_b64_tr_b16 v[200:201], v224 offset:4096
    ds_read_b64_tr_b16 v[202:203], v224 offset:4608
    ds_read_b128 v[172:175], v231 offset:4096
    v_mfma_f32_32x32x16_bf16 v[144:159], v[212:215], v[180:183], v[144:159]
    ds_read_b64_tr_b16 v[204:205], v225 offset:4096
    ds_read_b64_tr_b16 v[206:207], v225 offset:4608
    v_xor_b32 v230, 64, v228
    v_xor_b32 v231, 96, v228
    v_mfma_f32_32x32x16_bf16 v[96:111], v[216:219], v[184:187], v[96:111]
    s_sub_u32 s77, s77, 1
    s_cmp_lg_u32 s77, s57
    s_cselect_b32 s3, s58, 0
    s_sub_u32 s58, s58, 1
    v_mfma_f32_32x32x16_bf16 v[112:127], v[216:219], v[188:191], v[112:127]
    s_cmp_lg_u32 s3, 0
    v_mfma_f32_32x32x16_bf16 v[128:143], v[220:223], v[184:187], v[128:143]
    v_mfma_f32_32x32x16_bf16 v[144:159], v[220:223], v[188:191], v[144:159]
    s_cbranch_scc1 M_a0
    s_cmp_eq_u32 s58, -1
    s_cbranch_scc1 M_a0_d1
M_a0_r1:
    s_cmp_lg_u32 s77, s57
    s_cbranch_scc1 M_a0
    s_cmp_eq_u32 s77, 0
    s_cbranch_scc1 M_ab
    s_branch M_puba
M_a0_d0:
    v_dot2c_f32_bf16 v240, s40, v192
    v_dot2c_f32_bf16 v241, s40, v196
    v_dot2c_f32_bf16 v240, s40, v193
    v_dot2c_f32_bf16 v241, s40, v197
    v_dot2c_f32_bf16 v240, s40, v194
    v_dot2c_f32_bf16 v241, s40, v198
    v_dot2c_f32_bf16 v240, s40, v195
    v_dot2c_f32_bf16 v241, s40, v199
    v_dot2c_f32_bf16 v240, s40, v200
    v_dot2c_f32_bf16 v241, s40, v204
    v_dot2c_f32_bf16 v240, s40, v201
    v_dot2c_f32_bf16 v241, s40, v205
    v_dot2c_f32_bf16 v240, s40, v202
    v_dot2c_f32_bf16 v241, s40, v206
    v_dot2c_f32_bf16 v240, s40, v203
    v_dot2c_f32_bf16 v241, s40, v207
    s_branch M_a0_r0
M_a0_d1:
    v_dot2c_f32_bf16 v240, s40, v208
    v_dot2c_f32_bf16 v241, s40, v212
    v_dot2c_f32_bf16 v240, s40, v209
    v_dot2c_f32_bf16 v241, s40, v213
    v_dot2c_f32_bf16 v240, s40, v210
    v_dot2c_f32_bf16 v241, s40, v214
    v_dot2c_f32_bf16 v240, s40, v211
    v_dot2c_f32_bf16 v241, s40, v215
    v_dot2c_f32_bf16 v240, s40, v216
    v_dot2c_f32_bf16 v241, s40, v220
    v_dot2c_f32_bf16 v240, s40, v217
    v_dot2c_f32_bf16 v241, s40, v221
    v_dot2c_f32_bf16 v240, s40, v218
    v_dot2c_f32_bf16 v241, s40, v222
    v_dot2c_f32_bf16 v240, s40, v219
    v_dot2c_f32_bf16 v241, s40, v223
    s_branch M_a0_r1
M_a1i:
    ds_read_b128 v[160:163], v230
    ds_read_b64_tr_b16 v[192:193], v224 offset:0
    ds_read_b64_tr_b16 v[194:195], v224 offset:512
    ds_read_b128 v[164:167], v230 offset:4096
    ds_read_b64_tr_b16 v[196:197], v225 offset:0
    ds_read_b64_tr_b16 v[198:199], v225 offset:512
    ds_read_b128 v[168:171], v231
    ds_read_b64_tr_b16 v[200:201], v224 offset:4096
    ds_read_b64_tr_b16 v[202:203], v224 offset:4608
    ds_read_b128 v[172:175], v231 offset:4096
    ds_read_b64_tr_b16 v[204:205], v225 offset:4096
    ds_read_b64_tr_b16 v[206:207], v225 offset:4608
    v_xor_b32 v230, 64, v228
    v_xor_b32 v231, 0x60, v228
.p2align 3
M_a1:
    s_waitcnt lgkmcnt(0)
    v_mfma_f32_32x32x16_bf16 v[96:111], v[160:163], v[192:195], v[96:111]
    ds_read_b128 v[176:179], v230
    ds_read_b64_tr_b16 v[208:209], v224 offset:8192
    ds_read_b64_tr_b16 v[210:211], v224 offset:8704
    ds_read_b128 v[180:183], v230 offset:4096
    v_mfma_f32_32x32x16_bf16 v[112:127], v[164:167], v[192:195], v[112:127]
    ds_read_b64_tr_b16 v[212:213], v225 offset:8192
    ds_read_b64_tr_b16 v[214:215], v225 offset:8704
    ds_read_b128 v[184:187], v231
    ds_read_b64_tr_b16 v[216:217], v224 offset:12288
    v_mfma_f32_32x32x16_bf16 v[128:143], v[160:163], v[196:199], v[128:143]
    ds_read_b64_tr_b16 v[218:219], v224 offset:12800
    ds_read_b128 v[188:191], v231 offset:4096
    ds_read_b64_tr_b16 v[220:221], v225 offset:12288
    ds_read_b64_tr_b16 v[222:223], v225 offset:12800
    v_mfma_f32_32x32x16_bf16 v[144:159], v[164:167], v[196:199], v[144:159]
    s_add_u32 s42, s42, 16384
    s_cmp_eq_u32 s42, 65536
    s_cselect_b32 s43, s39, 16384
    s_cselect_b32 s42, 0, s42
    v_mfma_f32_32x32x16_bf16 v[96:111], v[168:171], v[200:203], v[96:111]
    v_add_u32 v224, s43, v224
    v_add_u32 v225, s43, v225
    s_add_u32 s41, s41, 16384
    s_cmp_eq_u32 s41, 81920
    v_mfma_f32_32x32x16_bf16 v[112:127], v[172:175], v[200:203], v[112:127]
    s_cselect_b32 s3, s38, 16384
    s_cselect_b32 s41, 0, s41
    v_add_u32 v228, s3, v228
    v_xor_b32 v230, 0, v228
    v_mfma_f32_32x32x16_bf16 v[128:143], v[168:171], v[204:207], v[128:143]
    v_xor_b32 v231, 32, v228
    s_cmp_eq_u32 s58, 0
    v_mfma_f32_32x32x16_bf16 v[144:159], v[172:175], v[204:207], v[144:159]
    s_cbranch_scc1 M_a1_d0
M_a1_r0:
    s_waitcnt lgkmcnt(0)
    v_mfma_f32_32x32x16_bf16 v[96:111], v[176:179], v[208:211], v[96:111]
    s_cmp_gt_u32 s77, 5
    s_cbranch_scc1 M_a1_nw
    s_waitcnt vmcnt(0)
M_a1_nw:
    s_barrier
    ds_read_b128 v[160:163], v230
    ds_read_b64_tr_b16 v[192:193], v224 offset:0
    v_mfma_f32_32x32x16_bf16 v[112:127], v[180:183], v[208:211], v[112:127]
    ds_read_b64_tr_b16 v[194:195], v224 offset:512
    ds_read_b128 v[164:167], v230 offset:4096
    ds_read_b64_tr_b16 v[196:197], v225 offset:0
    ds_read_b64_tr_b16 v[198:199], v225 offset:512
    v_mfma_f32_32x32x16_bf16 v[128:143], v[176:179], v[212:215], v[128:143]
    ds_read_b128 v[168:171], v231
    ds_read_b64_tr_b16 v[200:201], v224 offset:4096
    ds_read_b64_tr_b16 v[202:203], v224 offset:4608
    ds_read_b128 v[172:175], v231 offset:4096
    v_mfma_f32_32x32x16_bf16 v[144:159], v[180:183], v[212:215], v[144:159]
    ds_read_b64_tr_b16 v[204:205], v225 offset:4096
    ds_read_b64_tr_b16 v[206:207], v225 offset:4608
    v_xor_b32 v230, 64, v228
    v_xor_b32 v231, 96, v228
    v_mfma_f32_32x32x16_bf16 v[96:111], v[184:187], v[216:219], v[96:111]
    s_sub_u32 s77, s77, 1
    s_cmp_lg_u32 s77, s57
    s_cselect_b32 s3, s58, 0
    s_sub_u32 s58, s58, 1
    v_mfma_f32_32x32x16_bf16 v[112:127], v[188:191], v[216:219], v[112:127]
    s_cmp_lg_u32 s3, 0
    v_mfma_f32_32x32x16_bf16 v[128:143], v[184:187], v[220:223], v[128:143]
    v_mfma_f32_32x32x16_bf16 v[144:159], v[188:191], v[220:223], v[144:159]
    s_cbranch_scc1 M_a1
    s_cmp_eq_u32 s58, -1
    s_cbranch_scc1 M_a1_d1
M_a1_r1:
    s_cmp_lg_u32 s77, s57
    s_cbranch_scc1 M_a1
    s_cmp_eq_u32 s77, 0
    s_cbranch_scc1 M_ab
    s_branch M_puba
M_a1_d0:
    v_dot2c_f32_bf16 v240, s40, v192
    v_dot2c_f32_bf16 v241, s40, v196
    v_dot2c_f32_bf16 v240, s40, v193
    v_dot2c_f32_bf16 v241, s40, v197
    v_dot2c_f32_bf16 v240, s40, v194
    v_dot2c_f32_bf16 v241, s40, v198
    v_dot2c_f32_bf16 v240, s40, v195
    v_dot2c_f32_bf16 v241, s40, v199
    v_dot2c_f32_bf16 v240, s40, v200
    v_dot2c_f32_bf16 v241, s40, v204
    v_dot2c_f32_bf16 v240, s40, v201
    v_dot2c_f32_bf16 v241, s40, v205
    v_dot2c_f32_bf16 v240, s40, v202
    v_dot2c_f32_bf16 v241, s40, v206
    v_dot2c_f32_bf16 v240, s40, v203
    v_dot2c_f32_bf16 v241, s40, v207
    s_branch M_a1_r0
M_a1_d1:
    v_dot2c_f32_bf16 v240, s40, v208
    v_dot2c_f32_bf16 v241, s40, v212
    v_dot2c_f32_bf16 v240, s40, v209
    v_dot2c_f32_bf16 v241, s40, v213
    v_dot2c_f32_bf16 v240, s40, v210
    v_dot2c_f32_bf16 v241, s40, v214
    v_dot2c_f32_bf16 v240, s40, v211
    v_dot2c_f32_bf16 v241, s40, v215
    v_dot2c_f32_bf16 v240, s40, v216
    v_dot2c_f32_bf16 v241, s40, v220
    v_dot2c_f32_bf16 v240, s40, v217
    v_dot2c_f32_bf16 v241, s40, v221
    v_dot2c_f32_bf16 v240, s40, v218
    v_dot2c_f32_bf16 v241, s40, v222
    v_dot2c_f32_bf16 v240, s40, v219
    v_dot2c_f32_bf16 v241, s40, v223
    s_branch M_a1_r1
M_a2i:
    ds_read_b128 v[160:163], v230
    ds_read_b64_tr_b16 v[192:193], v224 offset:0
    ds_read_b64_tr_b16 v[194:195], v224 offset:512
    ds_read_b128 v[164:167], v230 offset:4096
    ds_read_b128 v[168:171], v231
    ds_read_b64_tr_b16 v[200:201], v224 offset:4096
    ds_read_b64_tr_b16 v[202:203], v224 offset:4608
    ds_read_b128 v[172:175], v231 offset:4096
    v_xor_b32 v230, 64, v228
    v_xor_b32 v231, 0x60, v228
.p2align 3
M_a2:
    s_waitcnt lgkmcnt(0)
    v_mfma_f32_32x32x16_bf16 v[128:143], v[192:195], v[160:163], v[128:143]
    ds_read_b128 v[176:179], v230
    ds_read_b64_tr_b16 v[208:209], v224 offset:8192
    ds_read_b64_tr_b16 v[210:211], v224 offset:8704
    ds_read_b128 v[180:183], v230 offset:4096
    ds_read_b128 v[184:187], v231
    ds_read_b64_tr_b16 v[216:217], v224 offset:12288
    ds_read_b64_tr_b16 v[218:219], v224 offset:12800
    v_mfma_f32_32x32x16_bf16 v[144:159], v[192:195], v[164:167], v[144:159]
    ds_read_b128 v[188:191], v231 offset:4096
    s_add_u32 s42, s42, 16384
    s_cmp_eq_u32 s42, 65536
    s_cselect_b32 s43, s39, 16384
    s_cselect_b32 s42, 0, s42
    v_add_u32 v224, s43, v224
    s_add_u32 s41, s41, 16384
    v_mfma_f32_32x32x16_bf16 v[128:143], v[200:203], v[168:171], v[128:143]
    s_cmp_eq_u32 s41, 81920
    s_cselect_b32 s3, s38, 16384
    s_cselect_b32 s41, 0, s41
    v_add_u32 v228, s3, v228
    v_xor_b32 v230, 0, v228
    v_xor_b32 v231, 32, v228
    s_cmp_eq_u32 s58, 0
    v_mfma_f32_32x32x16_bf16 v[144:159], v[200:203], v[172:175], v[144:159]
    s_cbranch_scc1 M_a2_d0
M_a2_r0:
    s_waitcnt lgkmcnt(0)
    v_mfma_f32_32x32x16_bf16 v[128:143], v[208:211], v[176:179], v[128:143]
    s_cmp_gt_u32 s77, 5
    s_cbranch_scc1 M_a2_nw
    s_waitcnt vmcnt(0)
M_a2_nw:
    s_barrier
    ds_read_b128 v[160:163], v230
    ds_read_b64_tr_b16 v[192:193], v224 offset:0
    ds_read_b64_tr_b16 v[194:195], v224 offset:512
    ds_read_b128 v[164:167], v230 offset:4096
    v_mfma_f32_32x32x16_bf16 v[144:159], v[208:211], v[180:183], v[144:159]
    ds_read_b128 v[168:171], v231
    ds_read_b64_tr_b16 v[200:201], v224 offset:4096
    ds_read_b64_tr_b16 v[202:203], v224 offset:4608
    ds_read_b128 v[172:175], v231 offset:4096
    v_xor_b32 v230, 64, v228
    v_xor_b32 v231, 96, v228
    v_mfma_f32_32x32x16_bf16 v[128:143], v[216:219], v[184:187], v[128:143]
    s_sub_u32 s77, s77, 1
    s_cmp_lg_u32 s77, s57
    s_cselect_b32 s3, s58, 0
    s_sub_u32 s58, s58, 1
    s_cmp_lg_u32 s3, 0
    v_mfma_f32_32x32x16_bf16 v[144:159], v[216:219], v[188:191], v[144:159]
    s_cbranch_scc1 M_a2
    s_cmp_eq_u32 s58, -1
    s_cbranch_scc1 M_a2_d1
M_a2_r1:
    s_cmp_lg_u32 s77, s57
    s_cbranch_scc1 M_a2
    s_cmp_eq_u32 s77, 0
    s_cbranch_scc1 M_ab
    s_branch M_puba
M_a2_d0:
    v_dot2c_f32_bf16 v240, s40, v192
    v_dot2c_f32_bf16 v240, s40, v193
    v_dot2c_f32_bf16 v240, s40, v194
    v_dot2c_f32_bf16 v240, s40, v195
    v_dot2c_f32_bf16 v240, s40, v200
    v_dot2c_f32_bf16 v240, s40, v201
    v_dot2c_f32_bf16 v240, s40, v202
    v_dot2c_f32_bf16 v240, s40, v203
    s_branch M_a2_r0
M_a2_d1:
    v_dot2c_f32_bf16 v240, s40, v208
    v_dot2c_f32_bf16 v240, s40, v209
    v_dot2c_f32_bf16 v240, s40, v210
    v_dot2c_f32_bf16 v240, s40, v211
    v_dot2c_f32_bf16 v240, s40, v216
    v_dot2c_f32_bf16 v240, s40, v217
    v_dot2c_f32_bf16 v240, s40, v218
    v_dot2c_f32_bf16 v240, s40, v219
    s_branch M_a2_r1
M_puba:
    s_mov_b32 s57, 0
    s_lshl_b32 s53, s29, 4
    s_add_u32 s53, s53, s31
    s_mul_i32 s53, s53, 768
    s_add_u32 s53, s53, 16023552
    s_bitcmp1_b32 s101, 0
    s_cselect_b32 s55, 0xffff0000, 0
    s_cmp_eq_u32 s36, 1
    s_cbranch_scc1 M_pubax
    s_sub_u32 s3, 7, s30
    s_lshl_b32 s3, s37, s3
    s_add_u32 s54, s53, s3
    v_lshlrev_b32 v248, 1, v255
    v_mov_b32 v232, v240
    v_mov_b32 v233, v241
    s_nop 1
    v_permlane32_swap_b32 v240, v232
    v_permlane32_swap_b32 v241, v233
    s_nop 1
    v_add_f32 v240, v240, v232
    v_add_f32 v241, v241, v233
    v_cvt_pk_bf16_f32 v232, v240, v240
    v_cvt_pk_bf16_f32 v233, v241, v241
    v_and_b32 v232, s55, v232
    v_and_b32 v233, s55, v233
    v_sub_f32 v240, v240, v232
    v_sub_f32 v241, v241, v233
    v_cvt_pk_bf16_f32 v232, v240, v240
    v_cvt_pk_bf16_f32 v233, v241, v241
    s_mov_b32 exec_hi, 0
    buffer_store_short v232, v248, s[24:27], s54 offen sc1
    s_cmp_eq_u32 s30, 1
    s_cbranch_scc1 M_pubay
    buffer_store_short v233, v248, s[24:27], s54 offen offset:64 sc1
M_pubay:
    s_mov_b32 exec_hi, -1
M_pubax:
    s_cmp_eq_u32 s52, 1
    s_cbranch_scc1 M_a1
    s_cmp_gt_u32 s52, 1
    s_cbranch_scc1 M_a2
    s_branch M_a0
M_ab:
    s_lshl_b32 s3, s59, 5
    v_xor_b32 v224, s3, v237
    s_add_u32 s3, s3, 32
    v_xor_b32 v225, s3, v237
    s_add_u32 s3, s3, 32
    v_xor_b32 v226, s3, v237
    s_add_u32 s3, s3, 32
    v_xor_b32 v227, s3, v237
    v_mov_b32 v240, 0
    v_mov_b32 v241, 0
    s_mov_b32 s77, 8
    s_mov_b32 s57, 6
    s_lshr_b32 s58, s101, 1
    s_waitcnt lgkmcnt(0)
M_bgo:
    s_cmp_eq_u32 s30, 1
    s_cbranch_scc1 M_b1i
M_b0i:
    v_mov_b32 v230, v228
    ds_read_b128 v[160:163], v230
    ds_read_b64_tr_b16 v[176:177], v224 offset:0
    ds_read_b64_tr_b16 v[178:179], v224 offset:1024
    ds_read_b128 v[164:167], v230 offset:4096
    ds_read_b64_tr_b16 v[180:181], v225 offset:0
    ds_read_b64_tr_b16 v[182:183], v225 offset:1024
    ds_read_b64_tr_b16 v[184:185], v226 offset:0
    ds_read_b64_tr_b16 v[186:187], v226 offset:1024
    v_xor_b32 v230, 32, v228
.p2align 3
M_b0:
    s_waitcnt lgkmcnt(0)
    v_mfma_f32_32x32x16_bf16 v[0:15], v[176:179], v[160:163], v[0:15]
    ds_read_b128 v[168:171], v230
    ds_read_b64_tr_b16 v[192:193], v224 offset:4096
    ds_read_b64_tr_b16 v[194:195], v224 offset:5120
    ds_read_b128 v[172:175], v230 offset:4096
    v_mfma_f32_32x32x16_bf16 v[16:31], v[176:179], v[164:167], v[16:31]
    ds_read_b64_tr_b16 v[196:197], v225 offset:4096
    ds_read_b64_tr_b16 v[198:199], v225 offset:5120
    ds_read_b64_tr_b16 v[200:201], v226 offset:4096
    ds_read_b64_tr_b16 v[202:203], v226 offset:5120
    v_mfma_f32_32x32x16_bf16 v[32:47], v[180:183], v[160:163], v[32:47]
    s_cmp_eq_u32 s77, 1
    s_cselect_b32 s39, 98304, s39
    s_add_u32 s42, s42, 16384
    s_cmp_eq_u32 s42, 65536
    v_mfma_f32_32x32x16_bf16 v[48:63], v[180:183], v[164:167], v[48:63]
    s_cselect_b32 s43, s39, 16384
    s_cselect_b32 s42, 0, s42
    v_add_u32 v224, s43, v224
    v_add_u32 v225, s43, v225
    v_mfma_f32_32x32x16_bf16 v[64:79], v[184:187], v[160:163], v[64:79]
    v_add_u32 v226, s43, v226
    v_xor_b32 v230, 64, v228
    s_cmp_eq_u32 s58, 0
    v_mfma_f32_32x32x16_bf16 v[80:95], v[184:187], v[164:167], v[80:95]
    s_cbranch_scc1 M_b0_d0
M_b0_r0:
    s_waitcnt lgkmcnt(0)
    v_mfma_f32_32x32x16_bf16 v[0:15], v[192:195], v[168:171], v[0:15]
    s_barrier
    ds_read_b128 v[160:163], v230
    ds_read_b64_tr_b16 v[176:177], v224 offset:0
    v_mfma_f32_32x32x16_bf16 v[16:31], v[192:195], v[172:175], v[16:31]
    ds_read_b64_tr_b16 v[178:179], v224 offset:1024
    ds_read_b128 v[164:167], v230 offset:4096
    ds_read_b64_tr_b16 v[180:181], v225 offset:0
    v_mfma_f32_32x32x16_bf16 v[32:47], v[196:199], v[168:171], v[32:47]
    ds_read_b64_tr_b16 v[182:183], v225 offset:1024
    ds_read_b64_tr_b16 v[184:185], v226 offset:0
    ds_read_b64_tr_b16 v[186:187], v226 offset:1024
    v_mfma_f32_32x32x16_bf16 v[48:63], v[196:199], v[172:175], v[48:63]
    v_xor_b32 v230, 96, v228
    s_cmp_eq_u32 s58, 0
    v_mfma_f32_32x32x16_bf16 v[64:79], v[200:203], v[168:171], v[64:79]
    v_mfma_f32_32x32x16_bf16 v[80:95], v[200:203], v[172:175], v[80:95]
    s_cbranch_scc1 M_b0_d1
M_b0_r1:
    s_waitcnt lgkmcnt(0)
    v_mfma_f32_32x32x16_bf16 v[0:15], v[176:179], v[160:163], v[0:15]
    ds_read_b128 v[168:171], v230
    ds_read_b64_tr_b16 v[192:193], v224 offset:4096
    ds_read_b64_tr_b16 v[194:195], v224 offset:5120
    ds_read_b128 v[172:175], v230 offset:4096
    ds_read_b64_tr_b16 v[196:197], v225 offset:4096
    v_mfma_f32_32x32x16_bf16 v[16:31], v[176:179], v[164:167], v[16:31]
    ds_read_b64_tr_b16 v[198:199], v225 offset:5120
    ds_read_b64_tr_b16 v[200:201], v226 offset:4096
    ds_read_b64_tr_b16 v[202:203], v226 offset:5120
    s_add_u32 s42, s42, 16384
    s_cmp_eq_u32 s42, 65536
    v_mfma_f32_32x32x16_bf16 v[32:47], v[180:183], v[160:163], v[32:47]
    s_cselect_b32 s43, s39, 16384
    s_cselect_b32 s42, 0, s42
    v_add_u32 v224, s43, v224
    v_add_u32 v225, s43, v225
    v_add_u32 v226, s43, v226
    v_mfma_f32_32x32x16_bf16 v[48:63], v[180:183], v[164:167], v[48:63]
    s_add_u32 s41, s41, 16384
    s_cmp_eq_u32 s41, 81920
    s_cselect_b32 s3, s38, 16384
    s_cselect_b32 s41, 0, s41
    v_add_u32 v228, s3, v228
    v_mfma_f32_32x32x16_bf16 v[64:79], v[184:187], v[160:163], v[64:79]
    v_xor_b32 v230, 0, v228
    s_cmp_eq_u32 s58, 0
    v_mfma_f32_32x32x16_bf16 v[80:95], v[184:187], v[164:167], v[80:95]
    s_cbranch_scc1 M_b0_d2
M_b0_r2:
    s_waitcnt lgkmcnt(0)
    v_mfma_f32_32x32x16_bf16 v[0:15], v[192:195], v[168:171], v[0:15]
    s_cmp_lg_u32 s77, 5
    s_cbranch_scc0 M_b0_w
M_b0_nw:
    s_barrier
    ds_read_b128 v[160:163], v230
    ds_read_b64_tr_b16 v[176:177], v224 offset:0
    v_mfma_f32_32x32x16_bf16 v[16:31], v[192:195], v[172:175], v[16:31]
    ds_read_b64_tr_b16 v[178:179], v224 offset:1024
    ds_read_b128 v[164:167], v230 offset:4096
    ds_read_b64_tr_b16 v[180:181], v225 offset:0
    ds_read_b64_tr_b16 v[182:183], v225 offset:1024
    v_mfma_f32_32x32x16_bf16 v[32:47], v[196:199], v[168:171], v[32:47]
    ds_read_b64_tr_b16 v[184:185], v226 offset:0
    ds_read_b64_tr_b16 v[186:187], v226 offset:1024
    v_xor_b32 v230, 32, v228
    s_sub_u32 s77, s77, 1
    v_mfma_f32_32x32x16_bf16 v[48:63], v[196:199], v[172:175], v[48:63]
    s_cmp_lg_u32 s77, s57
    s_cselect_b32 s3, s58, 0
    s_sub_u32 s58, s58, 1
    s_cmp_lg_u32 s3, 0
    v_mfma_f32_32x32x16_bf16 v[64:79], v[200:203], v[168:171], v[64:79]
    v_mfma_f32_32x32x16_bf16 v[80:95], v[200:203], v[172:175], v[80:95]
    s_cbranch_scc1 M_b0
    s_cmp_eq_u32 s58, -1
    s_cbranch_scc1 M_b0_d3
M_b0_r3:
    s_cmp_lg_u32 s77, s57
    s_cbranch_scc1 M_b0
    s_cmp_eq_u32 s77, 0
    s_cbranch_scc1 M_eb
    s_branch M_co
M_b0_w:
    s_waitcnt vmcnt(0)
    s_branch M_b0_nw
M_b0_d0:
    v_dot2c_f32_bf16 v240, s40, v176
    v_dot2c_f32_bf16 v241, s40, v180
    v_dot2c_f32_bf16 v242, s40, v184
    v_dot2c_f32_bf16 v240, s40, v177
    v_dot2c_f32_bf16 v241, s40, v181
    v_dot2c_f32_bf16 v242, s40, v185
    v_dot2c_f32_bf16 v240, s40, v178
    v_dot2c_f32_bf16 v241, s40, v182
    v_dot2c_f32_bf16 v242, s40, v186
    v_dot2c_f32_bf16 v240, s40, v179
    v_dot2c_f32_bf16 v241, s40, v183
    v_dot2c_f32_bf16 v242, s40, v187
    s_branch M_b0_r0
M_b0_d1:
    v_dot2c_f32_bf16 v240, s40, v192
    v_dot2c_f32_bf16 v241, s40, v196
    v_dot2c_f32_bf16 v242, s40, v200
    v_dot2c_f32_bf16 v240, s40, v193
    v_dot2c_f32_bf16 v241, s40, v197
    v_dot2c_f32_bf16 v242, s40, v201
    v_dot2c_f32_bf16 v240, s40, v194
    v_dot2c_f32_bf16 v241, s40, v198
    v_dot2c_f32_bf16 v242, s40, v202
    v_dot2c_f32_bf16 v240, s40, v195
    v_dot2c_f32_bf16 v241, s40, v199
    v_dot2c_f32_bf16 v242, s40, v203
    s_branch M_b0_r1
M_b0_d2:
    v_dot2c_f32_bf16 v240, s40, v176
    v_dot2c_f32_bf16 v241, s40, v180
    v_dot2c_f32_bf16 v242, s40, v184
    v_dot2c_f32_bf16 v240, s40, v177
    v_dot2c_f32_bf16 v241, s40, v181
    v_dot2c_f32_bf16 v242, s40, v185
    v_dot2c_f32_bf16 v240, s40, v178
    v_dot2c_f32_bf16 v241, s40, v182
    v_dot2c_f32_bf16 v242, s40, v186
    v_dot2c_f32_bf16 v240, s40, v179
    v_dot2c_f32_bf16 v241, s40, v183
    v_dot2c_f32_bf16 v242, s40, v187
    s_branch M_b0_r2
M_b0_d3:
    v_dot2c_f32_bf16 v240, s40, v192
    v_dot2c_f32_bf16 v241, s40, v196
    v_dot2c_f32_bf16 v242, s40, v200
    v_dot2c_f32_bf16 v240, s40, v193
    v_dot2c_f32_bf16 v241, s40, v197
    v_dot2c_f32_bf16 v242, s40, v201
    v_dot2c_f32_bf16 v240, s40, v194
    v_dot2c_f32_bf16 v241, s40, v198
    v_dot2c_f32_bf16 v242, s40, v202
    v_dot2c_f32_bf16 v240, s40, v195
    v_dot2c_f32_bf16 v241, s40, v199
    v_dot2c_f32_bf16 v242, s40, v203
    s_branch M_b0_r3
M_b1i:
    v_mov_b32 v230, v228
    ds_read_b128 v[160:163], v230
    ds_read_b64_tr_b16 v[176:177], v224 offset:0
    ds_read_b64_tr_b16 v[178:179], v224 offset:1024
    ds_read_b128 v[164:167], v230 offset:4096
    ds_read_b64_tr_b16 v[180:181], v225 offset:0
    ds_read_b64_tr_b16 v[182:183], v225 offset:1024
    ds_read_b64_tr_b16 v[184:185], v226 offset:0
    ds_read_b64_tr_b16 v[186:187], v226 offset:1024
    ds_read_b64_tr_b16 v[188:189], v227 offset:0
    ds_read_b64_tr_b16 v[190:191], v227 offset:1024
    v_xor_b32 v230, 32, v228
.p2align 3
M_b1:
    s_waitcnt lgkmcnt(0)
    v_mfma_f32_32x32x16_bf16 v[0:15], v[176:179], v[160:163], v[0:15]
    ds_read_b128 v[168:171], v230
    ds_read_b64_tr_b16 v[192:193], v224 offset:4096
    ds_read_b64_tr_b16 v[194:195], v224 offset:5120
    ds_read_b128 v[172:175], v230 offset:4096
    v_mfma_f32_32x32x16_bf16 v[16:31], v[176:179], v[164:167], v[16:31]
    ds_read_b64_tr_b16 v[196:197], v225 offset:4096
    ds_read_b64_tr_b16 v[198:199], v225 offset:5120
    ds_read_b64_tr_b16 v[200:201], v226 offset:4096
    ds_read_b64_tr_b16 v[202:203], v226 offset:5120
    v_mfma_f32_32x32x16_bf16 v[32:47], v[180:183], v[160:163], v[32:47]
    ds_read_b64_tr_b16 v[204:205], v227 offset:4096
    ds_read_b64_tr_b16 v[206:207], v227 offset:5120
    s_cmp_eq_u32 s77, 1
    s_cselect_b32 s39, 98304, s39
    v_mfma_f32_32x32x16_bf16 v[48:63], v[180:183], v[164:167], v[48:63]
    s_add_u32 s42, s42, 16384
    s_cmp_eq_u32 s42, 65536
    s_cselect_b32 s43, s39, 16384
    s_cselect_b32 s42, 0, s42
    v_mfma_f32_32x32x16_bf16 v[64:79], v[184:187], v[160:163], v[64:79]
    v_add_u32 v224, s43, v224
    v_add_u32 v225, s43, v225
    v_add_u32 v226, s43, v226
    v_add_u32 v227, s43, v227
    v_mfma_f32_32x32x16_bf16 v[80:95], v[184:187], v[164:167], v[80:95]
    v_xor_b32 v230, 64, v228
    s_cmp_eq_u32 s58, 0
    v_mfma_f32_32x32x16_bf16 v[96:111], v[188:191], v[160:163], v[96:111]
    v_mfma_f32_32x32x16_bf16 v[112:127], v[188:191], v[164:167], v[112:127]
    s_cbranch_scc1 M_b1_d0
M_b1_r0:
    s_waitcnt lgkmcnt(0)
    v_mfma_f32_32x32x16_bf16 v[0:15], v[192:195], v[168:171], v[0:15]
    s_barrier
    ds_read_b128 v[160:163], v230
    v_mfma_f32_32x32x16_bf16 v[16:31], v[192:195], v[172:175], v[16:31]
    ds_read_b64_tr_b16 v[176:177], v224 offset:0
    ds_read_b64_tr_b16 v[178:179], v224 offset:1024
    v_mfma_f32_32x32x16_bf16 v[32:47], v[196:199], v[168:171], v[32:47]
    ds_read_b128 v[164:167], v230 offset:4096
    ds_read_b64_tr_b16 v[180:181], v225 offset:0
    v_mfma_f32_32x32x16_bf16 v[48:63], v[196:199], v[172:175], v[48:63]
    ds_read_b64_tr_b16 v[182:183], v225 offset:1024
    ds_read_b64_tr_b16 v[184:185], v226 offset:0
    v_mfma_f32_32x32x16_bf16 v[64:79], v[200:203], v[168:171], v[64:79]
    ds_read_b64_tr_b16 v[186:187], v226 offset:1024
    ds_read_b64_tr_b16 v[188:189], v227 offset:0
    v_mfma_f32_32x32x16_bf16 v[80:95], v[200:203], v[172:175], v[80:95]
    ds_read_b64_tr_b16 v[190:191], v227 offset:1024
    v_xor_b32 v230, 96, v228
    v_mfma_f32_32x32x16_bf16 v[96:111], v[204:207], v[168:171], v[96:111]
    s_cmp_eq_u32 s58, 0
    v_mfma_f32_32x32x16_bf16 v[112:127], v[204:207], v[172:175], v[112:127]
    s_cbranch_scc1 M_b1_d1
M_b1_r1:
    s_waitcnt lgkmcnt(0)
    v_mfma_f32_32x32x16_bf16 v[0:15], v[176:179], v[160:163], v[0:15]
    ds_read_b128 v[168:171], v230
    ds_read_b64_tr_b16 v[192:193], v224 offset:4096
    ds_read_b64_tr_b16 v[194:195], v224 offset:5120
    ds_read_b128 v[172:175], v230 offset:4096
    v_mfma_f32_32x32x16_bf16 v[16:31], v[176:179], v[164:167], v[16:31]
    ds_read_b64_tr_b16 v[196:197], v225 offset:4096
    ds_read_b64_tr_b16 v[198:199], v225 offset:5120
    ds_read_b64_tr_b16 v[200:201], v226 offset:4096
    ds_read_b64_tr_b16 v[202:203], v226 offset:5120
    v_mfma_f32_32x32x16_bf16 v[32:47], v[180:183], v[160:163], v[32:47]
    ds_read_b64_tr_b16 v[204:205], v227 offset:4096
    ds_read_b64_tr_b16 v[206:207], v227 offset:5120
    s_add_u32 s42, s42, 16384
    s_cmp_eq_u32 s42, 65536
    v_mfma_f32_32x32x16_bf16 v[48:63], v[180:183], v[164:167], v[48:63]
    s_cselect_b32 s43, s39, 16384
    s_cselect_b32 s42, 0, s42
    v_add_u32 v224, s43, v224
    v_add_u32 v225, s43, v225
    v_mfma_f32_32x32x16_bf16 v[64:79], v[184:187], v[160:163], v[64:79]
    v_add_u32 v226, s43, v226
    v_add_u32 v227, s43, v227
    s_add_u32 s41, s41, 16384
    s_cmp_eq_u32 s41, 81920
    v_mfma_f32_32x32x16_bf16 v[80:95], v[184:187], v[164:167], v[80:95]
    s_cselect_b32 s3, s38, 16384
    s_cselect_b32 s41, 0, s41
    v_add_u32 v228, s3, v228
    v_xor_b32 v230, 0, v228
    v_mfma_f32_32x32x16_bf16 v[96:111], v[188:191], v[160:163], v[96:111]
    s_cmp_eq_u32 s58, 0
    v_mfma_f32_32x32x16_bf16 v[112:127], v[188:191], v[164:167], v[112:127]
    s_cbranch_scc1 M_b1_d2
M_b1_r2:
    s_waitcnt lgkmcnt(0)
    v_mfma_f32_32x32x16_bf16 v[0:15], v[192:195], v[168:171], v[0:15]
    s_cmp_lg_u32 s77, 5
    s_cbranch_scc0 M_b1_w
M_b1_nw:
    s_barrier
    ds_read_b128 v[160:163], v230
    v_mfma_f32_32x32x16_bf16 v[16:31], v[192:195], v[172:175], v[16:31]
    ds_read_b64_tr_b16 v[176:177], v224 offset:0
    ds_read_b64_tr_b16 v[178:179], v224 offset:1024
    ds_read_b128 v[164:167], v230 offset:4096
    v_mfma_f32_32x32x16_bf16 v[32:47], v[196:199], v[168:171], v[32:47]
    ds_read_b64_tr_b16 v[180:181], v225 offset:0
    ds_read_b64_tr_b16 v[182:183], v225 offset:1024
    ds_read_b64_tr_b16 v[184:185], v226 offset:0
    v_mfma_f32_32x32x16_bf16 v[48:63], v[196:199], v[172:175], v[48:63]
    ds_read_b64_tr_b16 v[186:187], v226 offset:1024
    ds_read_b64_tr_b16 v[188:189], v227 offset:0
    ds_read_b64_tr_b16 v[190:191], v227 offset:1024
    v_mfma_f32_32x32x16_bf16 v[64:79], v[200:203], v[168:171], v[64:79]
    v_xor_b32 v230, 32, v228
    s_sub_u32 s77, s77, 1
    s_cmp_lg_u32 s77, s57
    v_mfma_f32_32x32x16_bf16 v[80:95], v[200:203], v[172:175], v[80:95]
    s_cselect_b32 s3, s58, 0
    s_sub_u32 s58, s58, 1
    s_cmp_lg_u32 s3, 0
    v_mfma_f32_32x32x16_bf16 v[96:111], v[204:207], v[168:171], v[96:111]
    v_mfma_f32_32x32x16_bf16 v[112:127], v[204:207], v[172:175], v[112:127]
    s_cbranch_scc1 M_b1
    s_cmp_eq_u32 s58, -1
    s_cbranch_scc1 M_b1_d3
M_b1_r3:
    s_cmp_lg_u32 s77, s57
    s_cbranch_scc1 M_b1
    s_cmp_eq_u32 s77, 0
    s_cbranch_scc1 M_eb
    s_branch M_co
M_b1_w:
    s_waitcnt vmcnt(0)
    s_branch M_b1_nw
M_b1_d0:
    v_dot2c_f32_bf16 v240, s40, v176
    v_dot2c_f32_bf16 v241, s40, v180
    v_dot2c_f32_bf16 v242, s40, v184
    v_dot2c_f32_bf16 v243, s40, v188
    v_dot2c_f32_bf16 v240, s40, v177
    v_dot2c_f32_bf16 v241, s40, v181
    v_dot2c_f32_bf16 v242, s40, v185
    v_dot2c_f32_bf16 v243, s40, v189
    v_dot2c_f32_bf16 v240, s40, v178
    v_dot2c_f32_bf16 v241, s40, v182
    v_dot2c_f32_bf16 v242, s40, v186
    v_dot2c_f32_bf16 v243, s40, v190
    v_dot2c_f32_bf16 v240, s40, v179
    v_dot2c_f32_bf16 v241, s40, v183
    v_dot2c_f32_bf16 v242, s40, v187
    v_dot2c_f32_bf16 v243, s40, v191
    s_branch M_b1_r0
M_b1_d1:
    v_dot2c_f32_bf16 v240, s40, v192
    v_dot2c_f32_bf16 v241, s40, v196
    v_dot2c_f32_bf16 v242, s40, v200
    v_dot2c_f32_bf16 v243, s40, v204
    v_dot2c_f32_bf16 v240, s40, v193
    v_dot2c_f32_bf16 v241, s40, v197
    v_dot2c_f32_bf16 v242, s40, v201
    v_dot2c_f32_bf16 v243, s40, v205
    v_dot2c_f32_bf16 v240, s40, v194
    v_dot2c_f32_bf16 v241, s40, v198
    v_dot2c_f32_bf16 v242, s40, v202
    v_dot2c_f32_bf16 v243, s40, v206
    v_dot2c_f32_bf16 v240, s40, v195
    v_dot2c_f32_bf16 v241, s40, v199
    v_dot2c_f32_bf16 v242, s40, v203
    v_dot2c_f32_bf16 v243, s40, v207
    s_branch M_b1_r1
M_b1_d2:
    v_dot2c_f32_bf16 v240, s40, v176
    v_dot2c_f32_bf16 v241, s40, v180
    v_dot2c_f32_bf16 v242, s40, v184
    v_dot2c_f32_bf16 v243, s40, v188
    v_dot2c_f32_bf16 v240, s40, v177
    v_dot2c_f32_bf16 v241, s40, v181
    v_dot2c_f32_bf16 v242, s40, v185
    v_dot2c_f32_bf16 v243, s40, v189
    v_dot2c_f32_bf16 v240, s40, v178
    v_dot2c_f32_bf16 v241, s40, v182
    v_dot2c_f32_bf16 v242, s40, v186
    v_dot2c_f32_bf16 v243, s40, v190
    v_dot2c_f32_bf16 v240, s40, v179
    v_dot2c_f32_bf16 v241, s40, v183
    v_dot2c_f32_bf16 v242, s40, v187
    v_dot2c_f32_bf16 v243, s40, v191
    s_branch M_b1_r2
M_b1_d3:
    v_dot2c_f32_bf16 v240, s40, v192
    v_dot2c_f32_bf16 v241, s40, v196
    v_dot2c_f32_bf16 v242, s40, v200
    v_dot2c_f32_bf16 v243, s40, v204
    v_dot2c_f32_bf16 v240, s40, v193
    v_dot2c_f32_bf16 v241, s40, v197
    v_dot2c_f32_bf16 v242, s40, v201
    v_dot2c_f32_bf16 v243, s40, v205
    v_dot2c_f32_bf16 v240, s40, v194
    v_dot2c_f32_bf16 v241, s40, v198
    v_dot2c_f32_bf16 v242, s40, v202
    v_dot2c_f32_bf16 v243, s40, v206
    v_dot2c_f32_bf16 v240, s40, v195
    v_dot2c_f32_bf16 v241, s40, v199
    v_dot2c_f32_bf16 v242, s40, v203
    v_dot2c_f32_bf16 v243, s40, v207
    s_branch M_b1_r3
M_co:
    v_and_b32 v244, 31, v255
    s_lshl_b32 s47, s36, 8
    s_add_u32 s47, s47, 159744
    v_lshl_add_u32 v250, v244, 2, s47
    v_xor_b32 v245, 64, v229
    ds_read2_b32 v[232:233], v250 offset0:0 offset1:128
    ds_read2_b32 v[234:235], v250 offset0:32 offset1:160
    ds_read_b64_tr_b16 v[168:169], v229
    ds_read_b64_tr_b16 v[170:171], v229 offset:512
    ds_read_b64_tr_b16 v[172:173], v245
    ds_read_b64_tr_b16 v[174:175], v245 offset:512
    v_mov_b32 v253, 161280
    ds_read_b32 v252, v253
    v_lshrrev_b32 v245, 5, v255
    v_lshl_add_u32 v250, v245, 4, s47
    ds_read_b128 v[192:195], v250 offset:0
    ds_read_b128 v[196:199], v250 offset:32
    ds_read_b128 v[200:203], v250 offset:64
    ds_read_b128 v[204:207], v250 offset:96
    s_mov_b32 s57, 0
    s_lshl_b32 s48, s31, 2
    s_lshl_b32 s3, s36, 1
    s_add_u32 s48, s48, s3
    s_lshr_b32 s49, s29, 1
    s_lshl_b32 s49, s49, 8
    s_add_u32 s49, s49, s48
    s_lshl_b32 s3, s59, 5
    s_add_u32 s53, s53, s3
    v_and_b32 v249, 15, v255
    v_lshlrev_b32 v249, 1, v249
    v_bfe_u32 v248, v255, 4, 1
    v_lshl_add_u32 v249, v248, 8, v249
    v_lshl_add_u32 v249, v245, 5, v249
    v_permlane32_swap_b32 v240, v241
    v_permlane32_swap_b32 v242, v243
    s_waitcnt lgkmcnt(9)
    v_mov_b32 v208, v233
    v_mov_b32 v209, v233
    v_mov_b32 v210, v233
    v_mov_b32 v211, v233
    v_mov_b32 v212, v235
    v_mov_b32 v213, v235
    v_mov_b32 v214, v235
    v_mov_b32 v215, v235
    s_waitcnt lgkmcnt(4)
    v_readfirstlane_b32 s35, v252
    s_cmp_eq_u32 s52, 1
    s_cbranch_scc1 M_e1
    s_cmp_gt_u32 s52, 1
    s_cbranch_scc1 M_e2
    v_mfma_f32_32x32x16_bf16 v[96:111], v[168:171], v[208:211], v[96:111]
    v_add_f32 v240, v240, v241
    v_add_f32 v242, v242, v243
    s_cmp_eq_u32 s36, 0
    s_cselect_b64 vcc, -1, 0
    s_lshl_b32 s3, s36, 6
    v_mfma_f32_32x32x16_bf16 v[112:127], v[168:171], v[212:215], v[112:127]
    s_add_u32 s53, s53, s3
    v_cndmask_b32 v240, v242, v240, vcc
    v_cvt_pk_bf16_f32 v241, v240, v240
    v_and_b32 v241, s55, v241
    v_mfma_f32_32x32x16_bf16 v[128:143], v[172:175], v[208:211], v[128:143]
    v_sub_f32 v240, v240, v241
    v_cvt_pk_bf16_f32 v240, v240, v240
    s_mov_b32 exec_hi, vcc_lo
    buffer_store_short v240, v249, s[24:27], s53 offen offset:256 sc1
    s_mov_b32 exec_hi, -1
    s_mov_b32 s3, 1052289595
    v_mfma_f32_32x32x16_bf16 v[144:159], v[172:175], v[212:215], v[144:159]
    s_lshl_b32 s50, s49, 10
    s_add_u32 s50, s50, 0
    v_mul_f32 v236, s3, v232
    v_mul_f32 v238, s3, v234
    v_pk_mul_f32 v[96:97], v[96:97], v[236:237] op_sel_hi:[1,0]
    v_pk_mul_f32 v[98:99], v[98:99], v[236:237] op_sel_hi:[1,0]
    v_pk_mul_f32 v[100:101], v[100:101], v[236:237] op_sel_hi:[1,0]
    v_pk_mul_f32 v[102:103], v[102:103], v[236:237] op_sel_hi:[1,0]
    v_pk_mul_f32 v[104:105], v[104:105], v[236:237] op_sel_hi:[1,0]
    v_pk_mul_f32 v[106:107], v[106:107], v[236:237] op_sel_hi:[1,0]
    v_pk_mul_f32 v[108:109], v[108:109], v[236:237] op_sel_hi:[1,0]
    v_pk_mul_f32 v[110:111], v[110:111], v[236:237] op_sel_hi:[1,0]
    v_cvt_pk_bf16_f32 v96, v96, v97
    v_cvt_pk_bf16_f32 v97, v98, v99
    v_cvt_pk_bf16_f32 v98, v100, v101
    v_cvt_pk_bf16_f32 v99, v102, v103
    s_add_u32 s3, s50, 0
    buffer_store_dwordx4 v[96:99], v251, s[24:27], s3 offen offset:0 sc1
    v_cvt_pk_bf16_f32 v104, v104, v105
    v_cvt_pk_bf16_f32 v105, v106, v107
    v_cvt_pk_bf16_f32 v106, v108, v109
    v_cvt_pk_bf16_f32 v107, v110, v111
    s_add_u32 s3, s50, 65536
    buffer_store_dwordx4 v[104:107], v251, s[24:27], s3 offen offset:0 sc1
    v_pk_mul_f32 v[112:113], v[112:113], v[238:239] op_sel_hi:[1,0]
    v_pk_mul_f32 v[114:115], v[114:115], v[238:239] op_sel_hi:[1,0]
    v_pk_mul_f32 v[116:117], v[116:117], v[238:239] op_sel_hi:[1,0]
    v_pk_mul_f32 v[118:119], v[118:119], v[238:239] op_sel_hi:[1,0]
    v_pk_mul_f32 v[120:121], v[120:121], v[238:239] op_sel_hi:[1,0]
    v_pk_mul_f32 v[122:123], v[122:123], v[238:239] op_sel_hi:[1,0]
    v_pk_mul_f32 v[124:125], v[124:125], v[238:239] op_sel_hi:[1,0]
    v_pk_mul_f32 v[126:127], v[126:127], v[238:239] op_sel_hi:[1,0]
    v_cvt_pk_bf16_f32 v112, v112, v113
    v_cvt_pk_bf16_f32 v113, v114, v115
    v_cvt_pk_bf16_f32 v114, v116, v117
    v_cvt_pk_bf16_f32 v115, v118, v119
    s_add_u32 s3, s50, 0
    buffer_store_dwordx4 v[112:115], v251, s[24:27], s3 offen offset:1024 sc1
    v_cvt_pk_bf16_f32 v120, v120, v121
    v_cvt_pk_bf16_f32 v121, v122, v123
    v_cvt_pk_bf16_f32 v122, v124, v125
    v_cvt_pk_bf16_f32 v123, v126, v127
    s_add_u32 s3, s50, 65536
    buffer_store_dwordx4 v[120:123], v251, s[24:27], s3 offen offset:1024 sc1
    v_pk_mul_f32 v[128:129], v[128:129], v[236:237] op_sel_hi:[1,0]
    v_pk_mul_f32 v[130:131], v[130:131], v[236:237] op_sel_hi:[1,0]
    v_pk_mul_f32 v[132:133], v[132:133], v[236:237] op_sel_hi:[1,0]
    v_pk_mul_f32 v[134:135], v[134:135], v[236:237] op_sel_hi:[1,0]
    v_pk_mul_f32 v[136:137], v[136:137], v[236:237] op_sel_hi:[1,0]
    v_pk_mul_f32 v[138:139], v[138:139], v[236:237] op_sel_hi:[1,0]
    v_pk_mul_f32 v[140:141], v[140:141], v[236:237] op_sel_hi:[1,0]
    v_pk_mul_f32 v[142:143], v[142:143], v[236:237] op_sel_hi:[1,0]
    v_cvt_pk_bf16_f32 v128, v128, v129
    v_cvt_pk_bf16_f32 v129, v130, v131
    v_cvt_pk_bf16_f32 v130, v132, v133
    v_cvt_pk_bf16_f32 v131, v134, v135
    s_add_u32 s3, s50, 131072
    buffer_store_dwordx4 v[128:131], v251, s[24:27], s3 offen offset:0 sc1
    v_cvt_pk_bf16_f32 v136, v136, v137
    v_cvt_pk_bf16_f32 v137, v138, v139
    v_cvt_pk_bf16_f32 v138, v140, v141
    v_cvt_pk_bf16_f32 v139, v142, v143
    s_add_u32 s3, s50, 196608
    buffer_store_dwordx4 v[136:139], v251, s[24:27], s3 offen offset:0 sc1
    v_pk_mul_f32 v[144:145], v[144:145], v[238:239] op_sel_hi:[1,0]
    v_pk_mul_f32 v[146:147], v[146:147], v[238:239] op_sel_hi:[1,0]
    v_pk_mul_f32 v[148:149], v[148:149], v[238:239] op_sel_hi:[1,0]
    v_pk_mul_f32 v[150:151], v[150:151], v[238:239] op_sel_hi:[1,0]
    v_pk_mul_f32 v[152:153], v[152:153], v[238:239] op_sel_hi:[1,0]
    v_pk_mul_f32 v[154:155], v[154:155], v[238:239] op_sel_hi:[1,0]
    v_pk_mul_f32 v[156:157], v[156:157], v[238:239] op_sel_hi:[1,0]
    v_pk_mul_f32 v[158:159], v[158:159], v[238:239] op_sel_hi:[1,0]
    v_cvt_pk_bf16_f32 v144, v144, v145
    v_cvt_pk_bf16_f32 v145, v146, v147
    v_cvt_pk_bf16_f32 v146, v148, v149
    v_cvt_pk_bf16_f32 v147, v150, v151
    s_add_u32 s3, s50, 131072
    buffer_store_dwordx4 v[144:147], v251, s[24:27], s3 offen offset:1024 sc1
    v_cvt_pk_bf16_f32 v152, v152, v153
    v_cvt_pk_bf16_f32 v153, v154, v155
    v_cvt_pk_bf16_f32 v154, v156, v157
    v_cvt_pk_bf16_f32 v155, v158, v159
    s_add_u32 s3, s50, 196608
    buffer_store_dwordx4 v[152:155], v251, s[24:27], s3 offen offset:1024 sc1
    s_branch M_b0
M_e1:
    v_mfma_f32_32x32x16_bf16 v[96:111], v[208:211], v[168:171], v[96:111]
    v_add_f32 v240, v240, v241
    v_add_f32 v242, v242, v243
    s_cmp_eq_u32 s36, 0
    s_cselect_b64 vcc, -1, 0
    s_lshl_b32 s3, s36, 6
    v_mfma_f32_32x32x16_bf16 v[128:143], v[208:211], v[172:175], v[128:143]
    s_add_u32 s53, s53, s3
    v_cndmask_b32 v240, v242, v240, vcc
    v_cvt_pk_bf16_f32 v241, v240, v240
    v_and_b32 v241, s55, v241
    v_sub_f32 v240, v240, v241
    v_mfma_f32_32x32x16_bf16 v[112:127], v[212:215], v[168:171], v[112:127]
    v_cvt_pk_bf16_f32 v240, v240, v240
    s_mov_b32 exec_hi, vcc_lo
    buffer_store_short v240, v249, s[24:27], s53 offen offset:256 sc1
    s_mov_b32 exec_hi, -1
    v_and_b32 v244, 15, v255
    v_lshlrev_b32 v244, 4, v244
    v_lshl_add_u32 v244, v245, 8, v244
    v_mfma_f32_32x32x16_bf16 v[144:159], v[212:215], v[172:175], v[144:159]
    v_lshl_add_u32 v244, v248, 17, v244
    s_lshl_b32 s50, s49, 11
    s_add_u32 s50, s50, 2098176
    s_add_u32 s51, s50, 262144
    s_waitcnt lgkmcnt(0)
    v_pk_mul_f32 v[96:97], v[96:97], v[192:193]
    v_pk_mul_f32 v[98:99], v[98:99], v[194:195]
    v_pk_mul_f32 v[100:101], v[100:101], v[196:197]
    v_pk_mul_f32 v[102:103], v[102:103], v[198:199]
    v_pk_mul_f32 v[104:105], v[104:105], v[200:201]
    v_pk_mul_f32 v[106:107], v[106:107], v[202:203]
    v_pk_mul_f32 v[108:109], v[108:109], v[204:205]
    v_pk_mul_f32 v[110:111], v[110:111], v[206:207]
    v_cvt_pk_bf16_f32 v216, v96, v97
    v_cvt_pk_bf16_f32 v217, v98, v99
    v_cvt_pk_bf16_f32 v218, v100, v101
    v_cvt_pk_bf16_f32 v219, v102, v103
    buffer_store_dwordx4 v[216:219], v244, s[24:27], s50 offen offset:0 sc1
    v_cvt_pk_bf16_f32 v220, v104, v105
    v_cvt_pk_bf16_f32 v221, v106, v107
    v_cvt_pk_bf16_f32 v222, v108, v109
    v_cvt_pk_bf16_f32 v223, v110, v111
    buffer_store_dwordx4 v[220:223], v244, s[24:27], s50 offen offset:512 sc1
    ds_read_b128 v[96:99], v250 offset:128
    ds_read_b128 v[100:103], v250 offset:160
    ds_read_b128 v[104:107], v250 offset:192
    ds_read_b128 v[108:111], v250 offset:224
    v_pk_mul_f32 v[128:129], v[128:129], v[192:193]
    v_pk_mul_f32 v[130:131], v[130:131], v[194:195]
    v_pk_mul_f32 v[132:133], v[132:133], v[196:197]
    v_pk_mul_f32 v[134:135], v[134:135], v[198:199]
    v_pk_mul_f32 v[136:137], v[136:137], v[200:201]
    v_pk_mul_f32 v[138:139], v[138:139], v[202:203]
    v_pk_mul_f32 v[140:141], v[140:141], v[204:205]
    v_pk_mul_f32 v[142:143], v[142:143], v[206:207]
    v_cvt_pk_bf16_f32 v128, v128, v129
    v_cvt_pk_bf16_f32 v129, v130, v131
    v_cvt_pk_bf16_f32 v130, v132, v133
    v_cvt_pk_bf16_f32 v131, v134, v135
    buffer_store_dwordx4 v[128:131], v244, s[24:27], s51 offen offset:0 sc1
    v_cvt_pk_bf16_f32 v136, v136, v137
    v_cvt_pk_bf16_f32 v137, v138, v139
    v_cvt_pk_bf16_f32 v138, v140, v141
    v_cvt_pk_bf16_f32 v139, v142, v143
    buffer_store_dwordx4 v[136:139], v244, s[24:27], s51 offen offset:512 sc1
    s_waitcnt lgkmcnt(0)
    v_pk_mul_f32 v[112:113], v[112:113], v[96:97]
    v_pk_mul_f32 v[114:115], v[114:115], v[98:99]
    v_pk_mul_f32 v[116:117], v[116:117], v[100:101]
    v_pk_mul_f32 v[118:119], v[118:119], v[102:103]
    v_pk_mul_f32 v[120:121], v[120:121], v[104:105]
    v_pk_mul_f32 v[122:123], v[122:123], v[106:107]
    v_pk_mul_f32 v[124:125], v[124:125], v[108:109]
    v_pk_mul_f32 v[126:127], v[126:127], v[110:111]
    v_cvt_pk_bf16_f32 v112, v112, v113
    v_cvt_pk_bf16_f32 v113, v114, v115
    v_cvt_pk_bf16_f32 v114, v116, v117
    v_cvt_pk_bf16_f32 v115, v118, v119
    buffer_store_dwordx4 v[112:115], v244, s[24:27], s50 offen offset:2048 sc1
    v_cvt_pk_bf16_f32 v120, v120, v121
    v_cvt_pk_bf16_f32 v121, v122, v123
    v_cvt_pk_bf16_f32 v122, v124, v125
    v_cvt_pk_bf16_f32 v123, v126, v127
    buffer_store_dwordx4 v[120:123], v244, s[24:27], s50 offen offset:2560 sc1
    v_pk_mul_f32 v[144:145], v[144:145], v[96:97]
    v_pk_mul_f32 v[146:147], v[146:147], v[98:99]
    v_pk_mul_f32 v[148:149], v[148:149], v[100:101]
    v_pk_mul_f32 v[150:151], v[150:151], v[102:103]
    v_pk_mul_f32 v[152:153], v[152:153], v[104:105]
    v_pk_mul_f32 v[154:155], v[154:155], v[106:107]
    v_pk_mul_f32 v[156:157], v[156:157], v[108:109]
    v_pk_mul_f32 v[158:159], v[158:159], v[110:111]
    v_cvt_pk_bf16_f32 v144, v144, v145
    v_cvt_pk_bf16_f32 v145, v146, v147
    v_cvt_pk_bf16_f32 v146, v148, v149
    v_cvt_pk_bf16_f32 v147, v150, v151
    buffer_store_dwordx4 v[144:147], v244, s[24:27], s51 offen offset:2048 sc1
    v_cvt_pk_bf16_f32 v152, v152, v153
    v_cvt_pk_bf16_f32 v153, v154, v155
    v_cvt_pk_bf16_f32 v154, v156, v157
    v_cvt_pk_bf16_f32 v155, v158, v159
    buffer_store_dwordx4 v[152:155], v244, s[24:27], s51 offen offset:2560 sc1
    s_branch M_b0
M_e2:
    v_mfma_f32_32x32x16_bf16 v[128:143], v[168:171], v[208:211], v[128:143]
    v_add_f32 v240, v240, v241
    v_add_f32 v242, v242, v243
    s_cmp_eq_u32 s36, 0
    s_cselect_b64 vcc, -1, 0
    s_lshl_b32 s3, s36, 6
    v_mfma_f32_32x32x16_bf16 v[144:159], v[168:171], v[212:215], v[144:159]
    s_add_u32 s53, s53, s3
    v_cndmask_b32 v240, v242, v240, vcc
    v_cvt_pk_bf16_f32 v241, v240, v240
    v_and_b32 v241, s55, v241
    v_sub_f32 v240, v240, v241
    v_cvt_pk_bf16_f32 v240, v240, v240
    buffer_store_short v240, v249, s[24:27], s53 offen offset:256 sc1
    v_and_b32 v244, 0x33, v255
    v_bfe_u32 v245, v255, 2, 1
    v_lshl_add_u32 v244, v245, 3, v244
    v_bfe_u32 v245, v255, 3, 1
    v_lshl_add_u32 v244, v245, 2, v244
    v_lshlrev_b32 v244, 4, v244
    s_lshl_b32 s3, s37, 7
    s_add_u32 s50, s49, s3
    s_lshl_b32 s50, s50, 11
    s_add_u32 s50, s50, 2097152
    v_pk_mul_f32 v[128:129], v[128:129], v[232:233] op_sel_hi:[1,0]
    v_pk_mul_f32 v[130:131], v[130:131], v[232:233] op_sel_hi:[1,0]
    v_pk_mul_f32 v[132:133], v[132:133], v[232:233] op_sel_hi:[1,0]
    v_pk_mul_f32 v[134:135], v[134:135], v[232:233] op_sel_hi:[1,0]
    v_pk_mul_f32 v[136:137], v[136:137], v[232:233] op_sel_hi:[1,0]
    v_pk_mul_f32 v[138:139], v[138:139], v[232:233] op_sel_hi:[1,0]
    v_pk_mul_f32 v[140:141], v[140:141], v[232:233] op_sel_hi:[1,0]
    v_pk_mul_f32 v[142:143], v[142:143], v[232:233] op_sel_hi:[1,0]
    v_cvt_pk_bf16_f32 v128, v128, v129
    v_cvt_pk_bf16_f32 v129, v130, v131
    v_cvt_pk_bf16_f32 v130, v132, v133
    v_cvt_pk_bf16_f32 v131, v134, v135
    s_add_u32 s3, s50, 0
    buffer_store_dwordx4 v[128:131], v244, s[24:27], s3 offen offset:0 sc1
    v_cvt_pk_bf16_f32 v136, v136, v137
    v_cvt_pk_bf16_f32 v137, v138, v139
    v_cvt_pk_bf16_f32 v138, v140, v141
    v_cvt_pk_bf16_f32 v139, v142, v143
    s_add_u32 s3, s50, 131072
    buffer_store_dwordx4 v[136:139], v244, s[24:27], s3 offen offset:0 sc1
    v_pk_mul_f32 v[144:145], v[144:145], v[234:235] op_sel_hi:[1,0]
    v_pk_mul_f32 v[146:147], v[146:147], v[234:235] op_sel_hi:[1,0]
    v_pk_mul_f32 v[148:149], v[148:149], v[234:235] op_sel_hi:[1,0]
    v_pk_mul_f32 v[150:151], v[150:151], v[234:235] op_sel_hi:[1,0]
    v_pk_mul_f32 v[152:153], v[152:153], v[234:235] op_sel_hi:[1,0]
    v_pk_mul_f32 v[154:155], v[154:155], v[234:235] op_sel_hi:[1,0]
    v_pk_mul_f32 v[156:157], v[156:157], v[234:235] op_sel_hi:[1,0]
    v_pk_mul_f32 v[158:159], v[158:159], v[234:235] op_sel_hi:[1,0]
    v_cvt_pk_bf16_f32 v144, v144, v145
    v_cvt_pk_bf16_f32 v145, v146, v147
    v_cvt_pk_bf16_f32 v146, v148, v149
    v_cvt_pk_bf16_f32 v147, v150, v151
    s_add_u32 s3, s50, 0
    buffer_store_dwordx4 v[144:147], v244, s[24:27], s3 offen offset:2048 sc1
    v_cvt_pk_bf16_f32 v152, v152, v153
    v_cvt_pk_bf16_f32 v153, v154, v155
    v_cvt_pk_bf16_f32 v154, v156, v157
    v_cvt_pk_bf16_f32 v155, v158, v159
    s_add_u32 s3, s50, 131072
    buffer_store_dwordx4 v[152:155], v244, s[24:27], s3 offen offset:2048 sc1
    s_branch M_b1
M_eb:
    s_waitcnt lgkmcnt(0)
    s_cmp_eq_u32 s30, 0
    s_cbranch_scc1 M_eb3
    v_mfma_f32_32x32x16_bf16 v[96:111], v[188:191], v[208:211], v[96:111]
    v_mfma_f32_32x32x16_bf16 v[112:127], v[188:191], v[212:215], v[112:127]
M_eb3:
    v_mfma_f32_32x32x16_bf16 v[0:15], v[176:179], v[208:211], v[0:15]
    s_lshl_b32 s54, s34, 2
    s_add_u32 s54, s54, s28
    s_lshr_b32 s50, s29, 1
    s_and_b32 s51, s50, 1
    s_mul_i32 s50, s50, 14
    s_lshl_b32 s3, s51, 1
    s_sub_u32 s50, s50, s3
    v_mfma_f32_32x32x16_bf16 v[16:31], v[176:179], v[212:215], v[16:31]
    s_xor_b32 s51, s51, s30
    s_xor_b32 s51, s51, 1
    s_lshl_b32 s51, s51, 3
    s_add_u32 s50, s50, s51
    s_add_u32 s50, s50, s59
    s_mul_i32 s3, s48, 112
    s_add_u32 s50, s50, s3
    v_mfma_f32_32x32x16_bf16 v[32:47], v[180:183], v[208:211], v[32:47]
    s_lshl_b32 s50, s50, 10
    s_add_u32 s50, s50, 6291456
    s_add_u32 s51, s50, 114688
    s_mov_b32 s56, 0x0000ffff
    s_mov_b32 s57, 0x0000ffff
    s_mov_b32 s46, 0x00110000
    s_mov_b32 s47, 0x00110000
    v_mfma_f32_32x32x16_bf16 v[48:63], v[180:183], v[212:215], v[48:63]
    s_lshl_b32 s3, s36, 11
    v_add_u32 v144, s3, v251
    v_and_b32 v244, 15, v255
    v_lshlrev_b32 v244, 4, v244
    v_lshrrev_b32 v245, 5, v255
    v_lshl_add_u32 v145, v245, 8, v244
    s_add_u32 s3, s3, 1024
    v_mfma_f32_32x32x16_bf16 v[64:79], v[184:187], v[208:211], v[64:79]
    v_add_u32 v145, s3, v145
    v_mov_b32 v146, 0xdddddddd
    v_mov_b32 v248, 0
    v_mov_b32 v249, 0
    v_mov_b32 v148, s40
    v_mov_b32 v149, s40
    v_cndmask_b32 v128, v248, v148, s[46:47]
    v_mfma_f32_32x32x16_bf16 v[80:95], v[184:187], v[212:215], v[80:95]
    s_lshl_b32 s3, s28, 12
    s_add_u32 s3, s3, 131072
    v_add_u32 v147, s3, v251
    v_and_b32 v244, 31, v255
    v_lshl_add_u32 v150, v244, 3, s3
    s_lshl_b32 s38, s33, 17
    s_add_u32 s38, s38, 2097152
    s_lshl_b32 s55, s54, 6
    s_add_u32 s55, s55, s33
    s_lshl_b32 s55, s55, 10
    s_add_u32 s55, s55, 13631488
    s_add_u32 s62, s55, 0x8000
    s_lshl_b32 s52, s54, 5
    s_add_u32 s52, s52, s33
    s_mul_i32 s52, s52, 384
    s_add_u32 s52, s52, 16252928
    v_mov_b32 v129, v128
    v_mov_b32 v130, v128
    v_mov_b32 v131, v128
    v_mov_b32 v132, v128
    v_mov_b32 v133, v128
    v_mov_b32 v134, v128
    v_mov_b32 v135, v128
    v_mov_b32 v136, v128
    v_mov_b32 v137, v128
    v_mov_b32 v138, v128
    v_mov_b32 v139, v128
    v_mov_b32 v140, v128
    v_mov_b32 v141, v128
    v_mov_b32 v142, v128
    v_mov_b32 v143, v128
    s_cmp_eq_u32 s30, 0
    s_cbranch_scc1 M_eg2
    v_max_f32 v96, 0, v96
    v_max_f32 v97, 0, v97
    v_max_f32 v98, 0, v98
    v_max_f32 v99, 0, v99
    v_max_f32 v100, 0, v100
    v_max_f32 v101, 0, v101
    v_max_f32 v102, 0, v102
    v_max_f32 v103, 0, v103
    v_pk_mul_f32 v[96:97], v[96:97], v[104:105]
    v_pk_mul_f32 v[98:99], v[98:99], v[106:107]
    v_pk_mul_f32 v[100:101], v[100:101], v[108:109]
    v_pk_mul_f32 v[102:103], v[102:103], v[110:111]
    v_cvt_pk_bf16_f32 v240, v96, v97
    v_cvt_pk_bf16_f32 v241, v98, v99
    v_cvt_pk_bf16_f32 v242, v100, v101
    v_cvt_pk_bf16_f32 v243, v102, v103
    v_max_f32 v112, 0, v112
    v_max_f32 v113, 0, v113
    v_max_f32 v114, 0, v114
    v_max_f32 v115, 0, v115
    v_max_f32 v116, 0, v116
    v_max_f32 v117, 0, v117
    v_max_f32 v118, 0, v118
    v_max_f32 v119, 0, v119
    v_pk_mul_f32 v[112:113], v[112:113], v[120:121]
    v_pk_mul_f32 v[114:115], v[114:115], v[122:123]
    v_pk_mul_f32 v[116:117], v[116:117], v[124:125]
    v_pk_mul_f32 v[118:119], v[118:119], v[126:127]
    v_cvt_pk_bf16_f32 v244, v112, v113
    v_cvt_pk_bf16_f32 v245, v114, v115
    v_cvt_pk_bf16_f32 v246, v116, v117
    v_cvt_pk_bf16_f32 v247, v118, v119
M_eg2:
    v_max_f32 v0, 0, v0
    v_max_f32 v1, 0, v1
    v_max_f32 v2, 0, v2
    v_max_f32 v3, 0, v3
    v_max_f32 v4, 0, v4
    v_max_f32 v5, 0, v5
    v_max_f32 v6, 0, v6
    v_max_f32 v7, 0, v7
    v_pk_mul_f32 v[0:1], v[0:1], v[8:9]
    v_pk_mul_f32 v[2:3], v[2:3], v[10:11]
    v_pk_mul_f32 v[4:5], v[4:5], v[12:13]
    v_pk_mul_f32 v[6:7], v[6:7], v[14:15]
    v_cvt_pk_bf16_f32 v216, v0, v1
    v_cvt_pk_bf16_f32 v217, v2, v3
    v_cvt_pk_bf16_f32 v218, v4, v5
    v_cvt_pk_bf16_f32 v219, v6, v7
    v_max_f32 v16, 0, v16
    v_max_f32 v17, 0, v17
    v_max_f32 v18, 0, v18
    v_max_f32 v19, 0, v19
    v_max_f32 v20, 0, v20
    v_max_f32 v21, 0, v21
    v_max_f32 v22, 0, v22
    v_max_f32 v23, 0, v23
    v_pk_mul_f32 v[16:17], v[16:17], v[24:25]
    v_pk_mul_f32 v[18:19], v[18:19], v[26:27]
    v_pk_mul_f32 v[20:21], v[20:21], v[28:29]
    v_pk_mul_f32 v[22:23], v[22:23], v[30:31]
    v_cvt_pk_bf16_f32 v220, v16, v17
    v_cvt_pk_bf16_f32 v221, v18, v19
    v_cvt_pk_bf16_f32 v222, v20, v21
    v_cvt_pk_bf16_f32 v223, v22, v23
    v_max_f32 v32, 0, v32
    v_max_f32 v33, 0, v33
    v_max_f32 v34, 0, v34
    v_max_f32 v35, 0, v35
    v_max_f32 v36, 0, v36
    v_max_f32 v37, 0, v37
    v_max_f32 v38, 0, v38
    v_max_f32 v39, 0, v39
    v_pk_mul_f32 v[32:33], v[32:33], v[40:41]
    v_pk_mul_f32 v[34:35], v[34:35], v[42:43]
    v_pk_mul_f32 v[36:37], v[36:37], v[44:45]
    v_pk_mul_f32 v[38:39], v[38:39], v[46:47]
    v_cvt_pk_bf16_f32 v224, v32, v33
    v_cvt_pk_bf16_f32 v225, v34, v35
    v_cvt_pk_bf16_f32 v226, v36, v37
    v_cvt_pk_bf16_f32 v227, v38, v39
    v_max_f32 v48, 0, v48
    v_max_f32 v49, 0, v49
    v_max_f32 v50, 0, v50
    v_max_f32 v51, 0, v51
    v_max_f32 v52, 0, v52
    v_max_f32 v53, 0, v53
    v_max_f32 v54, 0, v54
    v_max_f32 v55, 0, v55
    v_pk_mul_f32 v[48:49], v[48:49], v[56:57]
    v_pk_mul_f32 v[50:51], v[50:51], v[58:59]
    v_pk_mul_f32 v[52:53], v[52:53], v[60:61]
    v_pk_mul_f32 v[54:55], v[54:55], v[62:63]
    v_cvt_pk_bf16_f32 v228, v48, v49
    v_cvt_pk_bf16_f32 v229, v50, v51
    v_cvt_pk_bf16_f32 v230, v52, v53
    v_cvt_pk_bf16_f32 v231, v54, v55
    v_max_f32 v64, 0, v64
    v_max_f32 v65, 0, v65
    v_max_f32 v66, 0, v66
    v_max_f32 v67, 0, v67
    v_max_f32 v68, 0, v68
    v_max_f32 v69, 0, v69
    v_max_f32 v70, 0, v70
    v_max_f32 v71, 0, v71
    v_pk_mul_f32 v[64:65], v[64:65], v[72:73]
    v_pk_mul_f32 v[66:67], v[66:67], v[74:75]
    v_pk_mul_f32 v[68:69], v[68:69], v[76:77]
    v_pk_mul_f32 v[70:71], v[70:71], v[78:79]
    v_cvt_pk_bf16_f32 v232, v64, v65
    v_cvt_pk_bf16_f32 v233, v66, v67
    v_cvt_pk_bf16_f32 v234, v68, v69
    v_cvt_pk_bf16_f32 v235, v70, v71
    v_max_f32 v80, 0, v80
    v_max_f32 v81, 0, v81
    v_max_f32 v82, 0, v82
    v_max_f32 v83, 0, v83
    v_max_f32 v84, 0, v84
    v_max_f32 v85, 0, v85
    v_max_f32 v86, 0, v86
    v_max_f32 v87, 0, v87
    v_pk_mul_f32 v[80:81], v[80:81], v[88:89]
    v_pk_mul_f32 v[82:83], v[82:83], v[90:91]
    v_pk_mul_f32 v[84:85], v[84:85], v[92:93]
    v_pk_mul_f32 v[86:87], v[86:87], v[94:95]
    v_cvt_pk_bf16_f32 v236, v80, v81
    v_cvt_pk_bf16_f32 v237, v82, v83
    v_cvt_pk_bf16_f32 v238, v84, v85
    v_cvt_pk_bf16_f32 v239, v86, v87
    v_mfma_f32_32x32x8_bf16 v[16:31], v[248:249], v[248:249], 0
    v_mfma_f32_32x32x8_bf16 v[80:95], v[248:249], v[248:249], 0
    v_mfma_f32_32x32x8_bf16 v[32:47], v[248:249], v[248:249], 0
    v_mfma_f32_32x32x8_bf16 v[48:63], v[248:249], v[248:249], 0
    v_mfma_f32_32x32x8_bf16 v[64:79], v[248:249], v[248:249], 0
    v_xor_b32 v120, 4096, v147
    v_xor_b32 v121, 4096, v150
    s_setprio 3
    s_mov_b32 s77, 0
    s_mov_b32 s60, 1
    s_barrier
    ds_read_b64 v[124:125], v121 offset:2048
    ds_read_b128 v[112:115], v144
    ds_read_b128 v[96:99], v120
    ds_read_b64 v[126:127], v121 offset:2304
    ds_read_b128 v[100:103], v120 offset:1024
    ds_read_b64 v[116:117], v150 offset:2048
    ds_read_b64 v[118:119], v150 offset:2304
    ds_read_b128 v[104:107], v147
    ds_read_b128 v[108:111], v147 offset:1024
    s_mov_b64 exec, s[56:57]
    ds_read_b128 v[128:131], v145 offset:0
    ds_read_b128 v[132:135], v145 offset:512
    s_mov_b64 exec, -1
    s_waitcnt lgkmcnt(10)
    v_mfma_f32_32x32x8_bf16 v[152:167], v[148:149], v[124:125], 0
    s_nop 8
    s_waitcnt lgkmcnt(8)
    v_mfma_f32_32x32x16_bf16 v[0:15], v[112:115], v[96:99], v[152:167]
    s_waitcnt lgkmcnt(4)
    v_mfma_f32_32x32x8_bf16 v[168:183], v[148:149], v[126:127], 0
    v_mfma_f32_32x32x8_bf16 v[184:199], v[148:149], v[116:117], 0
    v_mfma_f32_32x32x8_bf16 v[200:215], v[148:149], v[118:119], 0
    v_mov_b64 v[124:125], -1
    v_mov_b64 v[126:127], -1
    s_nop 5
    s_waitcnt lgkmcnt(0)
    v_exp_f32 v0, v0
    v_exp_f32 v1, v1
    v_exp_f32 v2, v2
    v_smfmac_f32_32x32x32_bf16 v[80:95], v[140:143], v[24:31], v146
    s_mov_b64 exec, s[56:57]
    ds_read_b128 v[136:139], v145 offset:4096
    ds_read_b128 v[140:143], v145 offset:4608
    s_mov_b64 exec, -1
    v_exp_f32 v3, v3
    v_exp_f32 v4, v4
    v_mfma_f32_32x32x16_bf16 v[16:31], v[112:115], v[100:103], v[168:183]
    v_exp_f32 v5, v5
    v_exp_f32 v6, v6
    v_exp_f32 v7, v7
    v_exp_f32 v8, v8
    v_exp_f32 v9, v9
    v_exp_f32 v10, v10
    v_smfmac_f32_32x32x32_bf16 v[32:47], v[128:131], v[0:7], v146
    buffer_store_dwordx4 v[216:219], v251, s[24:27], s50 offen offset:0 sc1
    v_exp_f32 v11, v11
    v_exp_f32 v12, v12
    v_exp_f32 v13, v13
    v_exp_f32 v14, v14
    v_exp_f32 v15, v15
    v_exp_f32 v16, v16
    v_exp_f32 v17, v17
    v_exp_f32 v18, v18
    v_smfmac_f32_32x32x32_bf16 v[32:47], v[132:135], v[8:15], v146
    ds_read_b128 v[116:119], v144 offset:4096
    v_exp_f32 v19, v19
    v_exp_f32 v20, v20
    v_mfma_f32_32x32x16_bf16 v[0:15], v[112:115], v[104:107], v[184:199]
    v_exp_f32 v21, v21
    v_exp_f32 v22, v22
    v_exp_f32 v23, v23
    v_exp_f32 v24, v24
    v_exp_f32 v25, v25
    v_exp_f32 v26, v26
    v_smfmac_f32_32x32x32_bf16 v[48:63], v[128:131], v[16:23], v146
    buffer_store_dwordx4 v[220:223], v251, s[24:27], s51 offen offset:0 sc1
    v_exp_f32 v27, v27
    v_exp_f32 v28, v28
    v_exp_f32 v29, v29
    v_exp_f32 v30, v30
    v_exp_f32 v31, v31
    v_exp_f32 v0, v0
    v_exp_f32 v1, v1
    v_exp_f32 v2, v2
    v_smfmac_f32_32x32x32_bf16 v[48:63], v[132:135], v[24:31], v146
    v_exp_f32 v3, v3
    v_exp_f32 v4, v4
    v_mfma_f32_32x32x16_bf16 v[16:31], v[112:115], v[108:111], v[200:215]
    v_exp_f32 v5, v5
    v_exp_f32 v6, v6
    v_exp_f32 v7, v7
    v_exp_f32 v8, v8
    v_exp_f32 v9, v9
    v_exp_f32 v10, v10
    v_smfmac_f32_32x32x32_bf16 v[64:79], v[128:131], v[0:7], v146
    buffer_store_dwordx4 v[224:227], v251, s[24:27], s50 offen offset:1024 sc1
    v_exp_f32 v11, v11
    v_exp_f32 v12, v12
    v_exp_f32 v13, v13
    v_exp_f32 v14, v14
    v_exp_f32 v15, v15
    v_exp_f32 v16, v16
    v_exp_f32 v17, v17
    v_exp_f32 v18, v18
    v_smfmac_f32_32x32x32_bf16 v[64:79], v[132:135], v[8:15], v146
    v_exp_f32 v19, v19
    v_exp_f32 v20, v20
    s_waitcnt lgkmcnt(0)
    v_mfma_f32_32x32x16_bf16 v[0:15], v[116:119], v[96:99], v[152:167]
    v_exp_f32 v21, v21
    v_exp_f32 v22, v22
    v_exp_f32 v23, v23
    v_exp_f32 v24, v24
    v_exp_f32 v25, v25
    v_exp_f32 v26, v26
    v_smfmac_f32_32x32x32_bf16 v[80:95], v[128:131], v[16:23], v146
    buffer_store_dwordx4 v[228:231], v251, s[24:27], s51 offen offset:1024 sc1
    v_exp_f32 v27, v27
    v_exp_f32 v28, v28
    v_exp_f32 v29, v29
    v_exp_f32 v30, v30
    v_exp_f32 v31, v31
    v_exp_f32 v0, v0
    v_exp_f32 v1, v1
    v_exp_f32 v2, v2
    v_smfmac_f32_32x32x32_bf16 v[80:95], v[132:135], v[24:31], v146
    s_mov_b64 exec, s[56:57]
    ds_read_b128 v[128:131], v145 offset:8192
    ds_read_b128 v[132:135], v145 offset:8704
    s_mov_b64 exec, -1
    v_exp_f32 v3, v3
    v_exp_f32 v4, v4
    v_mfma_f32_32x32x16_bf16 v[16:31], v[116:119], v[100:103], v[168:183]
    v_exp_f32 v5, v5
    v_exp_f32 v6, v6
    v_exp_f32 v7, v7
    v_exp_f32 v8, v8
    v_exp_f32 v9, v9
    v_exp_f32 v10, v10
    v_smfmac_f32_32x32x32_bf16 v[32:47], v[136:139], v[0:7], v146
    buffer_store_dwordx4 v[232:235], v251, s[24:27], s50 offen offset:2048 sc1
    v_exp_f32 v11, v11
    v_exp_f32 v12, v12
    v_exp_f32 v13, v13
    v_exp_f32 v14, v14
    v_exp_f32 v15, v15
    v_exp_f32 v16, v16
    v_exp_f32 v17, v17
    v_exp_f32 v18, v18
    v_smfmac_f32_32x32x32_bf16 v[32:47], v[140:143], v[8:15], v146
    ds_read_b128 v[112:115], v144 offset:8192
    v_exp_f32 v19, v19
    v_exp_f32 v20, v20
    v_mfma_f32_32x32x16_bf16 v[0:15], v[116:119], v[104:107], v[184:199]
    v_exp_f32 v21, v21
    v_exp_f32 v22, v22
    v_exp_f32 v23, v23
    v_exp_f32 v24, v24
    v_exp_f32 v25, v25
    v_exp_f32 v26, v26
    v_smfmac_f32_32x32x32_bf16 v[48:63], v[136:139], v[16:23], v146
    buffer_store_dwordx4 v[236:239], v251, s[24:27], s51 offen offset:2048 sc1
    v_exp_f32 v27, v27
    v_exp_f32 v28, v28
    v_exp_f32 v29, v29
    v_exp_f32 v30, v30
    v_exp_f32 v31, v31
    v_exp_f32 v0, v0
    v_exp_f32 v1, v1
    v_exp_f32 v2, v2
    v_smfmac_f32_32x32x32_bf16 v[48:63], v[140:143], v[24:31], v146
    v_exp_f32 v3, v3
    v_exp_f32 v4, v4
    v_mfma_f32_32x32x16_bf16 v[16:31], v[116:119], v[108:111], v[200:215]
    v_exp_f32 v5, v5
    v_exp_f32 v6, v6
    v_exp_f32 v7, v7
    v_exp_f32 v8, v8
    v_exp_f32 v9, v9
    v_exp_f32 v10, v10
    v_smfmac_f32_32x32x32_bf16 v[64:79], v[136:139], v[0:7], v146
    buffer_store_dwordx4 v[124:127], v251, s[24:27], s55 offen sc1
    s_cmp_eq_u32 s30, 0
    s_cbranch_scc1 M_hx6
    buffer_store_dwordx4 v[240:243], v251, s[24:27], s50 offen offset:3072 sc1
M_hx6:
    v_exp_f32 v11, v11
    v_exp_f32 v12, v12
    v_exp_f32 v13, v13
    v_exp_f32 v14, v14
    v_exp_f32 v15, v15
    v_exp_f32 v16, v16
    v_exp_f32 v17, v17
    v_exp_f32 v18, v18
    v_smfmac_f32_32x32x32_bf16 v[64:79], v[140:143], v[8:15], v146
    v_exp_f32 v19, v19
    v_exp_f32 v20, v20
    s_waitcnt lgkmcnt(0)
    v_mfma_f32_32x32x16_bf16 v[0:15], v[112:115], v[96:99], v[152:167]
    v_exp_f32 v21, v21
    v_exp_f32 v22, v22
    v_exp_f32 v23, v23
    v_exp_f32 v24, v24
    v_exp_f32 v25, v25
    v_exp_f32 v26, v26
    v_smfmac_f32_32x32x32_bf16 v[80:95], v[136:139], v[16:23], v146
    buffer_store_dwordx4 v[124:127], v251, s[24:27], s62 offen sc1
    s_cmp_eq_u32 s30, 0
    s_cbranch_scc1 M_hx7
    buffer_store_dwordx4 v[244:247], v251, s[24:27], s51 offen offset:3072 sc1
M_hx7:
    v_exp_f32 v27, v27
    v_exp_f32 v28, v28
    v_exp_f32 v29, v29
    v_exp_f32 v30, v30
    v_exp_f32 v31, v31
    s_branch M_al2
.p2align 6
M_aloop:
    v_exp_f32 v0, v0
    v_exp_f32 v1, v1
    v_exp_f32 v2, v2
    v_smfmac_f32_32x32x32_bf16 v[80:95], v[140:143], v[24:31], v146
    s_mov_b64 exec, s[56:57]
    ds_read_b128 v[136:139], v145 offset:4096
    ds_read_b128 v[140:143], v145 offset:4608
    s_mov_b64 exec, -1
    v_exp_f32 v3, v3
    v_exp_f32 v4, v4
    v_mfma_f32_32x32x16_bf16 v[16:31], v[112:115], v[100:103], v[168:183]
    v_exp_f32 v5, v5
    v_exp_f32 v6, v6
    v_exp_f32 v7, v7
    v_exp_f32 v8, v8
    v_exp_f32 v9, v9
    v_exp_f32 v10, v10
    v_smfmac_f32_32x32x32_bf16 v[32:47], v[128:131], v[0:7], v146
    v_exp_f32 v11, v11
    v_exp_f32 v12, v12
    v_exp_f32 v13, v13
    v_exp_f32 v14, v14
    v_exp_f32 v15, v15
    v_exp_f32 v16, v16
    v_exp_f32 v17, v17
    v_exp_f32 v18, v18
    v_smfmac_f32_32x32x32_bf16 v[32:47], v[132:135], v[8:15], v146
    ds_read_b128 v[116:119], v144 offset:4096
    v_exp_f32 v19, v19
    v_exp_f32 v20, v20
    v_mfma_f32_32x32x16_bf16 v[0:15], v[112:115], v[104:107], v[184:199]
    v_exp_f32 v21, v21
    v_exp_f32 v22, v22
    v_exp_f32 v23, v23
    v_exp_f32 v24, v24
    v_exp_f32 v25, v25
    v_exp_f32 v26, v26
    v_smfmac_f32_32x32x32_bf16 v[48:63], v[128:131], v[16:23], v146
    v_exp_f32 v27, v27
    v_exp_f32 v28, v28
    v_exp_f32 v29, v29
    v_exp_f32 v30, v30
    v_exp_f32 v31, v31
    v_exp_f32 v0, v0
    v_exp_f32 v1, v1
    v_exp_f32 v2, v2
    v_smfmac_f32_32x32x32_bf16 v[48:63], v[132:135], v[24:31], v146
    v_exp_f32 v3, v3
    v_exp_f32 v4, v4
    v_mfma_f32_32x32x16_bf16 v[16:31], v[112:115], v[108:111], v[200:215]
    v_exp_f32 v5, v5
    v_exp_f32 v6, v6
    v_exp_f32 v7, v7
    v_exp_f32 v8, v8
    v_exp_f32 v9, v9
    v_exp_f32 v10, v10
    v_smfmac_f32_32x32x32_bf16 v[64:79], v[128:131], v[0:7], v146
    v_exp_f32 v11, v11
    v_exp_f32 v12, v12
    v_exp_f32 v13, v13
    v_exp_f32 v14, v14
    v_exp_f32 v15, v15
    v_exp_f32 v16, v16
    v_exp_f32 v17, v17
    v_exp_f32 v18, v18
    v_smfmac_f32_32x32x32_bf16 v[64:79], v[132:135], v[8:15], v146
    v_exp_f32 v19, v19
    v_exp_f32 v20, v20
    s_waitcnt lgkmcnt(0)
    v_mfma_f32_32x32x16_bf16 v[0:15], v[116:119], v[96:99], v[152:167]
    v_exp_f32 v21, v21
    v_exp_f32 v22, v22
    v_exp_f32 v23, v23
    v_exp_f32 v24, v24
    v_exp_f32 v25, v25
    v_exp_f32 v26, v26
    v_smfmac_f32_32x32x32_bf16 v[80:95], v[128:131], v[16:23], v146
    v_exp_f32 v27, v27
    v_exp_f32 v28, v28
    v_exp_f32 v29, v29
    v_exp_f32 v30, v30
    v_exp_f32 v31, v31
    v_exp_f32 v0, v0
    v_exp_f32 v1, v1
    v_exp_f32 v2, v2
    v_smfmac_f32_32x32x32_bf16 v[80:95], v[132:135], v[24:31], v146
    s_mov_b64 exec, s[56:57]
    ds_read_b128 v[128:131], v145 offset:8192
    ds_read_b128 v[132:135], v145 offset:8704
    s_mov_b64 exec, -1
    v_exp_f32 v3, v3
    v_exp_f32 v4, v4
    v_mfma_f32_32x32x16_bf16 v[16:31], v[116:119], v[100:103], v[168:183]
    v_exp_f32 v5, v5
    v_exp_f32 v6, v6
    v_exp_f32 v7, v7
    v_exp_f32 v8, v8
    v_exp_f32 v9, v9
    v_exp_f32 v10, v10
    v_smfmac_f32_32x32x32_bf16 v[32:47], v[136:139], v[0:7], v146
    v_exp_f32 v11, v11
    v_exp_f32 v12, v12
    v_exp_f32 v13, v13
    v_exp_f32 v14, v14
    v_exp_f32 v15, v15
    v_exp_f32 v16, v16
    v_exp_f32 v17, v17
    v_exp_f32 v18, v18
    v_smfmac_f32_32x32x32_bf16 v[32:47], v[140:143], v[8:15], v146
    ds_read_b128 v[112:115], v144 offset:8192
    v_exp_f32 v19, v19
    v_exp_f32 v20, v20
    v_mfma_f32_32x32x16_bf16 v[0:15], v[116:119], v[104:107], v[184:199]
    v_exp_f32 v21, v21
    v_exp_f32 v22, v22
    v_exp_f32 v23, v23
    v_exp_f32 v24, v24
    v_exp_f32 v25, v25
    v_exp_f32 v26, v26
    v_smfmac_f32_32x32x32_bf16 v[48:63], v[136:139], v[16:23], v146
    v_exp_f32 v27, v27
    v_exp_f32 v28, v28
    v_exp_f32 v29, v29
    v_exp_f32 v30, v30
    v_exp_f32 v31, v31
    v_exp_f32 v0, v0
    v_exp_f32 v1, v1
    v_exp_f32 v2, v2
    v_smfmac_f32_32x32x32_bf16 v[48:63], v[140:143], v[24:31], v146
    v_exp_f32 v3, v3
    v_exp_f32 v4, v4
    v_mfma_f32_32x32x16_bf16 v[16:31], v[116:119], v[108:111], v[200:215]
    v_exp_f32 v5, v5
    v_exp_f32 v6, v6
    v_exp_f32 v7, v7
    v_exp_f32 v8, v8
    v_exp_f32 v9, v9
    v_exp_f32 v10, v10
    v_smfmac_f32_32x32x32_bf16 v[64:79], v[136:139], v[0:7], v146
    v_exp_f32 v11, v11
    v_exp_f32 v12, v12
    v_exp_f32 v13, v13
    v_exp_f32 v14, v14
    v_exp_f32 v15, v15
    v_exp_f32 v16, v16
    v_exp_f32 v17, v17
    v_exp_f32 v18, v18
    v_smfmac_f32_32x32x32_bf16 v[64:79], v[140:143], v[8:15], v146
    v_exp_f32 v19, v19
    v_exp_f32 v20, v20
    s_waitcnt lgkmcnt(0)
    v_mfma_f32_32x32x16_bf16 v[0:15], v[112:115], v[96:99], v[152:167]
    v_exp_f32 v21, v21
    v_exp_f32 v22, v22
    v_exp_f32 v23, v23
    v_exp_f32 v24, v24
    v_exp_f32 v25, v25
    v_exp_f32 v26, v26
    v_smfmac_f32_32x32x32_bf16 v[80:95], v[136:139], v[16:23], v146
    v_exp_f32 v27, v27
    v_exp_f32 v28, v28
    v_exp_f32 v29, v29
    v_exp_f32 v30, v30
    v_exp_f32 v31, v31
M_al2:
    v_exp_f32 v0, v0
    v_exp_f32 v1, v1
    v_exp_f32 v2, v2
    v_smfmac_f32_32x32x32_bf16 v[80:95], v[140:143], v[24:31], v146
    s_mov_b64 exec, s[56:57]
    ds_read_b128 v[136:139], v145 offset:12288
    ds_read_b128 v[140:143], v145 offset:12800
    s_mov_b64 exec, -1
    v_exp_f32 v3, v3
    v_exp_f32 v4, v4
    v_mfma_f32_32x32x16_bf16 v[16:31], v[112:115], v[100:103], v[168:183]
    v_exp_f32 v5, v5
    v_exp_f32 v6, v6
    v_exp_f32 v7, v7
    v_exp_f32 v8, v8
    v_exp_f32 v9, v9
    v_exp_f32 v10, v10
    v_smfmac_f32_32x32x32_bf16 v[32:47], v[128:131], v[0:7], v146
    v_exp_f32 v11, v11
    v_exp_f32 v12, v12
    v_exp_f32 v13, v13
    v_exp_f32 v14, v14
    v_exp_f32 v15, v15
    v_exp_f32 v16, v16
    v_exp_f32 v17, v17
    v_exp_f32 v18, v18
    v_smfmac_f32_32x32x32_bf16 v[32:47], v[132:135], v[8:15], v146
    ds_read_b128 v[116:119], v144 offset:12288
    v_exp_f32 v19, v19
    v_exp_f32 v20, v20
    v_mfma_f32_32x32x16_bf16 v[0:15], v[112:115], v[104:107], v[184:199]
    v_exp_f32 v21, v21
    v_exp_f32 v22, v22
    v_exp_f32 v23, v23
    v_exp_f32 v24, v24
    v_exp_f32 v25, v25
    v_exp_f32 v26, v26
    v_smfmac_f32_32x32x32_bf16 v[48:63], v[128:131], v[16:23], v146
    v_exp_f32 v27, v27
    v_exp_f32 v28, v28
    v_exp_f32 v29, v29
    v_exp_f32 v30, v30
    v_exp_f32 v31, v31
    v_exp_f32 v0, v0
    v_exp_f32 v1, v1
    v_exp_f32 v2, v2
    v_smfmac_f32_32x32x32_bf16 v[48:63], v[132:135], v[24:31], v146
    v_exp_f32 v3, v3
    v_exp_f32 v4, v4
    v_mfma_f32_32x32x16_bf16 v[16:31], v[112:115], v[108:111], v[200:215]
    v_exp_f32 v5, v5
    v_exp_f32 v6, v6
    v_exp_f32 v7, v7
    v_exp_f32 v8, v8
    v_exp_f32 v9, v9
    v_exp_f32 v10, v10
    v_smfmac_f32_32x32x32_bf16 v[64:79], v[128:131], v[0:7], v146
    v_exp_f32 v11, v11
    v_exp_f32 v12, v12
    v_exp_f32 v13, v13
    v_exp_f32 v14, v14
    v_exp_f32 v15, v15
    v_exp_f32 v16, v16
    v_exp_f32 v17, v17
    v_exp_f32 v18, v18
    v_smfmac_f32_32x32x32_bf16 v[64:79], v[132:135], v[8:15], v146
    v_exp_f32 v19, v19
    v_exp_f32 v20, v20
    s_waitcnt lgkmcnt(0)
    v_mfma_f32_32x32x16_bf16 v[0:15], v[116:119], v[96:99], v[152:167]
    v_exp_f32 v21, v21
    v_exp_f32 v22, v22
    v_exp_f32 v23, v23
    v_exp_f32 v24, v24
    v_exp_f32 v25, v25
    v_exp_f32 v26, v26
    v_smfmac_f32_32x32x32_bf16 v[80:95], v[128:131], v[16:23], v146
    v_exp_f32 v27, v27
    v_exp_f32 v28, v28
    v_exp_f32 v29, v29
    v_exp_f32 v30, v30
    v_exp_f32 v31, v31
    v_exp_f32 v0, v0
    v_exp_f32 v1, v1
    v_exp_f32 v2, v2
    v_smfmac_f32_32x32x32_bf16 v[80:95], v[132:135], v[24:31], v146
    s_mov_b64 exec, s[56:57]
    ds_read_b128 v[128:131], v145 offset:16384
    ds_read_b128 v[132:135], v145 offset:16896
    s_mov_b64 exec, -1
    v_exp_f32 v3, v3
    v_exp_f32 v4, v4
    v_mfma_f32_32x32x16_bf16 v[16:31], v[116:119], v[100:103], v[168:183]
    v_exp_f32 v5, v5
    v_exp_f32 v6, v6
    v_exp_f32 v7, v7
    v_exp_f32 v8, v8
    v_exp_f32 v9, v9
    v_exp_f32 v10, v10
    v_smfmac_f32_32x32x32_bf16 v[32:47], v[136:139], v[0:7], v146
    v_exp_f32 v11, v11
    v_exp_f32 v12, v12
    v_exp_f32 v13, v13
    v_exp_f32 v14, v14
    v_exp_f32 v15, v15
    v_exp_f32 v16, v16
    v_exp_f32 v17, v17
    v_exp_f32 v18, v18
    v_smfmac_f32_32x32x32_bf16 v[32:47], v[140:143], v[8:15], v146
    ds_read_b128 v[112:115], v144 offset:16384
    v_exp_f32 v19, v19
    v_exp_f32 v20, v20
    v_mfma_f32_32x32x16_bf16 v[0:15], v[116:119], v[104:107], v[184:199]
    v_exp_f32 v21, v21
    v_exp_f32 v22, v22
    v_exp_f32 v23, v23
    v_exp_f32 v24, v24
    v_exp_f32 v25, v25
    v_exp_f32 v26, v26
    v_smfmac_f32_32x32x32_bf16 v[48:63], v[136:139], v[16:23], v146
    v_exp_f32 v27, v27
    v_exp_f32 v28, v28
    v_exp_f32 v29, v29
    v_exp_f32 v30, v30
    v_exp_f32 v31, v31
    v_exp_f32 v0, v0
    v_exp_f32 v1, v1
    v_exp_f32 v2, v2
    v_smfmac_f32_32x32x32_bf16 v[48:63], v[140:143], v[24:31], v146
    v_exp_f32 v3, v3
    v_exp_f32 v4, v4
    v_mfma_f32_32x32x16_bf16 v[16:31], v[116:119], v[108:111], v[200:215]
    v_exp_f32 v5, v5
    v_exp_f32 v6, v6
    v_exp_f32 v7, v7
    v_exp_f32 v8, v8
    v_exp_f32 v9, v9
    v_exp_f32 v10, v10
    v_smfmac_f32_32x32x32_bf16 v[64:79], v[136:139], v[0:7], v146
    v_exp_f32 v11, v11
    v_exp_f32 v12, v12
    v_exp_f32 v13, v13
    v_exp_f32 v14, v14
    v_exp_f32 v15, v15
    v_exp_f32 v16, v16
    v_exp_f32 v17, v17
    v_exp_f32 v18, v18
    v_smfmac_f32_32x32x32_bf16 v[64:79], v[140:143], v[8:15], v146
    v_exp_f32 v19, v19
    v_exp_f32 v20, v20
    s_waitcnt lgkmcnt(0)
    v_mfma_f32_32x32x16_bf16 v[0:15], v[112:115], v[96:99], v[152:167]
    v_exp_f32 v21, v21
    v_exp_f32 v22, v22
    v_exp_f32 v23, v23
    v_exp_f32 v24, v24
    v_exp_f32 v25, v25
    v_exp_f32 v26, v26
    v_smfmac_f32_32x32x32_bf16 v[80:95], v[136:139], v[16:23], v146
    v_exp_f32 v27, v27
    v_exp_f32 v28, v28
    v_exp_f32 v29, v29
    v_exp_f32 v30, v30
    v_exp_f32 v31, v31
    v_exp_f32 v0, v0
    v_exp_f32 v1, v1
    v_exp_f32 v2, v2
    v_smfmac_f32_32x32x32_bf16 v[80:95], v[140:143], v[24:31], v146
    s_mov_b64 exec, s[56:57]
    ds_read_b128 v[136:139], v145 offset:20480
    ds_read_b128 v[140:143], v145 offset:20992
    s_mov_b64 exec, -1
    v_exp_f32 v3, v3
    v_exp_f32 v4, v4
    v_mfma_f32_32x32x16_bf16 v[16:31], v[112:115], v[100:103], v[168:183]
    v_exp_f32 v5, v5
    v_exp_f32 v6, v6
    v_exp_f32 v7, v7
    v_exp_f32 v8, v8
    v_exp_f32 v9, v9
    v_exp_f32 v10, v10
    v_smfmac_f32_32x32x32_bf16 v[32:47], v[128:131], v[0:7], v146
    v_exp_f32 v11, v11
    v_exp_f32 v12, v12
    v_exp_f32 v13, v13
    v_exp_f32 v14, v14
    v_exp_f32 v15, v15
    v_exp_f32 v16, v16
    v_exp_f32 v17, v17
    v_exp_f32 v18, v18
    v_smfmac_f32_32x32x32_bf16 v[32:47], v[132:135], v[8:15], v146
    ds_read_b128 v[116:119], v144 offset:20480
    v_exp_f32 v19, v19
    v_exp_f32 v20, v20
    v_mfma_f32_32x32x16_bf16 v[0:15], v[112:115], v[104:107], v[184:199]
    v_exp_f32 v21, v21
    v_exp_f32 v22, v22
    v_exp_f32 v23, v23
    v_exp_f32 v24, v24
    v_exp_f32 v25, v25
    v_exp_f32 v26, v26
    v_smfmac_f32_32x32x32_bf16 v[48:63], v[128:131], v[16:23], v146
    v_exp_f32 v27, v27
    v_exp_f32 v28, v28
    v_exp_f32 v29, v29
    v_exp_f32 v30, v30
    v_exp_f32 v31, v31
    v_exp_f32 v0, v0
    v_exp_f32 v1, v1
    v_exp_f32 v2, v2
    v_smfmac_f32_32x32x32_bf16 v[48:63], v[132:135], v[24:31], v146
    v_exp_f32 v3, v3
    v_exp_f32 v4, v4
    v_mfma_f32_32x32x16_bf16 v[16:31], v[112:115], v[108:111], v[200:215]
    v_exp_f32 v5, v5
    v_exp_f32 v6, v6
    v_exp_f32 v7, v7
    v_exp_f32 v8, v8
    v_exp_f32 v9, v9
    v_exp_f32 v10, v10
    v_smfmac_f32_32x32x32_bf16 v[64:79], v[128:131], v[0:7], v146
    v_exp_f32 v11, v11
    v_exp_f32 v12, v12
    v_exp_f32 v13, v13
    v_exp_f32 v14, v14
    v_exp_f32 v15, v15
    v_exp_f32 v16, v16
    v_exp_f32 v17, v17
    v_exp_f32 v18, v18
    v_smfmac_f32_32x32x32_bf16 v[64:79], v[132:135], v[8:15], v146
    v_exp_f32 v19, v19
    v_exp_f32 v20, v20
    s_waitcnt lgkmcnt(0)
    v_mfma_f32_32x32x16_bf16 v[0:15], v[116:119], v[96:99], v[152:167]
    v_exp_f32 v21, v21
    v_exp_f32 v22, v22
    v_exp_f32 v23, v23
    v_exp_f32 v24, v24
    v_exp_f32 v25, v25
    v_exp_f32 v26, v26
    v_smfmac_f32_32x32x32_bf16 v[80:95], v[128:131], v[16:23], v146
    v_exp_f32 v27, v27
    v_exp_f32 v28, v28
    v_exp_f32 v29, v29
    v_exp_f32 v30, v30
    v_exp_f32 v31, v31
    s_bitcmp1_b32 9, s77
    s_cbranch_scc1 M_hf
M_hfr:
    v_exp_f32 v0, v0
    v_exp_f32 v1, v1
    v_exp_f32 v2, v2
    v_smfmac_f32_32x32x32_bf16 v[80:95], v[132:135], v[24:31], v146
    s_mov_b64 exec, s[56:57]
    ds_read_b128 v[128:131], v145 offset:24576
    ds_read_b128 v[132:135], v145 offset:25088
    s_mov_b64 exec, -1
    v_exp_f32 v3, v3
    v_exp_f32 v4, v4
    v_mfma_f32_32x32x16_bf16 v[16:31], v[116:119], v[100:103], v[168:183]
    v_exp_f32 v5, v5
    v_exp_f32 v6, v6
    v_exp_f32 v7, v7
    v_exp_f32 v8, v8
    v_exp_f32 v9, v9
    v_exp_f32 v10, v10
    v_smfmac_f32_32x32x32_bf16 v[32:47], v[136:139], v[0:7], v146
    v_exp_f32 v11, v11
    v_exp_f32 v12, v12
    v_exp_f32 v13, v13
    v_exp_f32 v14, v14
    v_exp_f32 v15, v15
    v_exp_f32 v16, v16
    v_exp_f32 v17, v17
    v_exp_f32 v18, v18
    v_smfmac_f32_32x32x32_bf16 v[32:47], v[140:143], v[8:15], v146
    ds_read_b128 v[112:115], v144 offset:24576
    v_exp_f32 v19, v19
    v_exp_f32 v20, v20
    v_mfma_f32_32x32x16_bf16 v[0:15], v[116:119], v[104:107], v[184:199]
    v_exp_f32 v21, v21
    v_exp_f32 v22, v22
    v_exp_f32 v23, v23
    v_exp_f32 v24, v24
    v_exp_f32 v25, v25
    v_exp_f32 v26, v26
    v_smfmac_f32_32x32x32_bf16 v[48:63], v[136:139], v[16:23], v146
    v_exp_f32 v27, v27
    v_exp_f32 v28, v28
    v_exp_f32 v29, v29
    v_exp_f32 v30, v30
    v_exp_f32 v31, v31
    v_exp_f32 v0, v0
    v_exp_f32 v1, v1
    v_exp_f32 v2, v2
    v_smfmac_f32_32x32x32_bf16 v[48:63], v[140:143], v[24:31], v146
    v_exp_f32 v3, v3
    v_exp_f32 v4, v4
    v_mfma_f32_32x32x16_bf16 v[16:31], v[116:119], v[108:111], v[200:215]
    v_exp_f32 v5, v5
    v_exp_f32 v6, v6
    v_exp_f32 v7, v7
    v_exp_f32 v8, v8
    v_exp_f32 v9, v9
    v_exp_f32 v10, v10
    v_smfmac_f32_32x32x32_bf16 v[64:79], v[136:139], v[0:7], v146
    v_exp_f32 v11, v11
    v_exp_f32 v12, v12
    v_exp_f32 v13, v13
    v_exp_f32 v14, v14
    v_exp_f32 v15, v15
    v_exp_f32 v16, v16
    v_exp_f32 v17, v17
    v_exp_f32 v18, v18
    v_smfmac_f32_32x32x32_bf16 v[64:79], v[140:143], v[8:15], v146
    v_exp_f32 v19, v19
    v_exp_f32 v20, v20
    s_waitcnt lgkmcnt(0)
    v_mfma_f32_32x32x16_bf16 v[0:15], v[112:115], v[96:99], v[152:167]
    v_exp_f32 v21, v21
    v_exp_f32 v22, v22
    v_exp_f32 v23, v23
    v_exp_f32 v24, v24
    v_exp_f32 v25, v25
    v_exp_f32 v26, v26
    v_smfmac_f32_32x32x32_bf16 v[80:95], v[136:139], v[16:23], v146
    v_exp_f32 v27, v27
    v_exp_f32 v28, v28
    v_exp_f32 v29, v29
    v_exp_f32 v30, v30
    v_exp_f32 v31, v31
    v_exp_f32 v0, v0
    v_exp_f32 v1, v1
    v_exp_f32 v2, v2
    v_smfmac_f32_32x32x32_bf16 v[80:95], v[140:143], v[24:31], v146
    s_mov_b64 exec, s[56:57]
    ds_read_b128 v[136:139], v145 offset:28672
    ds_read_b128 v[140:143], v145 offset:29184
    s_mov_b64 exec, -1
    v_exp_f32 v3, v3
    v_exp_f32 v4, v4
    v_mfma_f32_32x32x16_bf16 v[16:31], v[112:115], v[100:103], v[168:183]
    v_exp_f32 v5, v5
    v_exp_f32 v6, v6
    v_exp_f32 v7, v7
    v_exp_f32 v8, v8
    v_exp_f32 v9, v9
    v_exp_f32 v10, v10
    v_smfmac_f32_32x32x32_bf16 v[32:47], v[128:131], v[0:7], v146
    v_exp_f32 v11, v11
    v_exp_f32 v12, v12
    v_exp_f32 v13, v13
    v_exp_f32 v14, v14
    v_exp_f32 v15, v15
    v_exp_f32 v16, v16
    v_exp_f32 v17, v17
    v_exp_f32 v18, v18
    v_smfmac_f32_32x32x32_bf16 v[32:47], v[132:135], v[8:15], v146
    ds_read_b128 v[116:119], v144 offset:28672
    v_exp_f32 v19, v19
    v_exp_f32 v20, v20
    v_mfma_f32_32x32x16_bf16 v[0:15], v[112:115], v[104:107], v[184:199]
    v_exp_f32 v21, v21
    v_exp_f32 v22, v22
    v_exp_f32 v23, v23
    v_exp_f32 v24, v24
    v_exp_f32 v25, v25
    v_exp_f32 v26, v26
    v_smfmac_f32_32x32x32_bf16 v[48:63], v[128:131], v[16:23], v146
    v_exp_f32 v27, v27
    v_exp_f32 v28, v28
    v_exp_f32 v29, v29
    v_exp_f32 v30, v30
    v_exp_f32 v31, v31
    v_exp_f32 v0, v0
    v_exp_f32 v1, v1
    v_exp_f32 v2, v2
    v_smfmac_f32_32x32x32_bf16 v[48:63], v[132:135], v[24:31], v146
    v_exp_f32 v3, v3
    v_exp_f32 v4, v4
    v_mfma_f32_32x32x16_bf16 v[16:31], v[112:115], v[108:111], v[200:215]
    v_exp_f32 v5, v5
    v_exp_f32 v6, v6
    v_exp_f32 v7, v7
    v_exp_f32 v8, v8
    v_exp_f32 v9, v9
    v_exp_f32 v10, v10
    v_smfmac_f32_32x32x32_bf16 v[64:79], v[128:131], v[0:7], v146
    v_exp_f32 v11, v11
    v_exp_f32 v12, v12
    v_exp_f32 v13, v13
    v_exp_f32 v14, v14
    v_exp_f32 v15, v15
    v_exp_f32 v16, v16
    v_exp_f32 v17, v17
    v_exp_f32 v18, v18
    v_smfmac_f32_32x32x32_bf16 v[64:79], v[132:135], v[8:15], v146
    v_exp_f32 v19, v19
    v_exp_f32 v20, v20
    s_waitcnt lgkmcnt(0)
    v_mfma_f32_32x32x16_bf16 v[0:15], v[116:119], v[96:99], v[152:167]
    v_exp_f32 v21, v21
    v_exp_f32 v22, v22
    v_exp_f32 v23, v23
    v_exp_f32 v24, v24
    v_exp_f32 v25, v25
    v_exp_f32 v26, v26
    v_smfmac_f32_32x32x32_bf16 v[80:95], v[128:131], v[16:23], v146
    v_exp_f32 v27, v27
    v_exp_f32 v28, v28
    v_exp_f32 v29, v29
    v_exp_f32 v30, v30
    v_exp_f32 v31, v31
    v_exp_f32 v0, v0
    v_exp_f32 v1, v1
    v_exp_f32 v2, v2
    v_smfmac_f32_32x32x32_bf16 v[80:95], v[132:135], v[24:31], v146
    s_mov_b64 exec, s[56:57]
    ds_read_b128 v[128:131], v145 offset:32768
    ds_read_b128 v[132:135], v145 offset:33280
    s_mov_b64 exec, -1
    v_exp_f32 v3, v3
    v_exp_f32 v4, v4
    v_mfma_f32_32x32x16_bf16 v[16:31], v[116:119], v[100:103], v[168:183]
    v_exp_f32 v5, v5
    v_exp_f32 v6, v6
    v_exp_f32 v7, v7
    v_exp_f32 v8, v8
    v_exp_f32 v9, v9
    v_exp_f32 v10, v10
    v_smfmac_f32_32x32x32_bf16 v[32:47], v[136:139], v[0:7], v146
    v_exp_f32 v11, v11
    v_exp_f32 v12, v12
    v_exp_f32 v13, v13
    v_exp_f32 v14, v14
    v_exp_f32 v15, v15
    v_exp_f32 v16, v16
    v_exp_f32 v17, v17
    v_exp_f32 v18, v18
    v_smfmac_f32_32x32x32_bf16 v[32:47], v[140:143], v[8:15], v146
    ds_read_b128 v[112:115], v144 offset:32768
    v_exp_f32 v19, v19
    v_exp_f32 v20, v20
    v_mfma_f32_32x32x16_bf16 v[0:15], v[116:119], v[104:107], v[184:199]
    v_exp_f32 v21, v21
    v_exp_f32 v22, v22
    v_exp_f32 v23, v23
    v_exp_f32 v24, v24
    v_exp_f32 v25, v25
    v_exp_f32 v26, v26
    v_smfmac_f32_32x32x32_bf16 v[48:63], v[136:139], v[16:23], v146
    v_exp_f32 v27, v27
    v_exp_f32 v28, v28
    v_exp_f32 v29, v29
    v_exp_f32 v30, v30
    v_exp_f32 v31, v31
    v_exp_f32 v0, v0
    v_exp_f32 v1, v1
    v_exp_f32 v2, v2
    v_smfmac_f32_32x32x32_bf16 v[48:63], v[140:143], v[24:31], v146
    v_exp_f32 v3, v3
    v_exp_f32 v4, v4
    v_mfma_f32_32x32x16_bf16 v[16:31], v[116:119], v[108:111], v[200:215]
    v_exp_f32 v5, v5
    v_exp_f32 v6, v6
    v_exp_f32 v7, v7
    v_exp_f32 v8, v8
    v_exp_f32 v9, v9
    v_exp_f32 v10, v10
    v_smfmac_f32_32x32x32_bf16 v[64:79], v[136:139], v[0:7], v146
    v_exp_f32 v11, v11
    v_exp_f32 v12, v12
    v_exp_f32 v13, v13
    v_exp_f32 v14, v14
    v_exp_f32 v15, v15
    v_exp_f32 v16, v16
    v_exp_f32 v17, v17
    v_exp_f32 v18, v18
    v_smfmac_f32_32x32x32_bf16 v[64:79], v[140:143], v[8:15], v146
    v_exp_f32 v19, v19
    v_exp_f32 v20, v20
    s_waitcnt lgkmcnt(0)
    v_mfma_f32_32x32x16_bf16 v[0:15], v[112:115], v[96:99], v[152:167]
    v_exp_f32 v21, v21
    v_exp_f32 v22, v22
    v_exp_f32 v23, v23
    v_exp_f32 v24, v24
    v_exp_f32 v25, v25
    v_exp_f32 v26, v26
    v_smfmac_f32_32x32x32_bf16 v[80:95], v[136:139], v[16:23], v146
    v_exp_f32 v27, v27
    v_exp_f32 v28, v28
    v_exp_f32 v29, v29
    v_exp_f32 v30, v30
    v_exp_f32 v31, v31
    v_add_u32 v144, 0x8000, v144
    v_add_u32 v145, 0x8000, v145
    s_add_u32 s77, s77, 1
    s_cmp_lg_u32 s77, s60
    s_cbranch_scc1 M_aloop
    s_cmp_eq_u32 s77, 4
    s_cbranch_scc1 M_adone
    s_mov_b32 s60, 4
    s_barrier
    s_branch M_aloop
M_adone:
    v_smfmac_f32_32x32x32_bf16 v[80:95], v[140:143], v[24:31], v146
    ds_write_b128 v124, v[32:35] offset:0
    ds_write_b128 v124, v[36:39] offset:1024
    ds_write_b32 v125, v40 offset:4096
    ds_write_b128 v124, v[48:51] offset:2048
    ds_write_b128 v124, v[52:55] offset:3072
    ds_write_b32 v125, v56 offset:4352
    s_mov_b32 s60, 0x7e800000
    s_mov_b32 s61, 0xa800000
    s_lshl_b32 s63, s33, 2
    s_add_u32 s63, s63, s28
    s_mul_i32 s63, s63, 3072
    s_add_u32 s63, s63, 16252928
    v_and_b32 v144, 7, v255
    v_mul_u32_u24 v144, 384, v144
    buffer_load_dword v145, v144, s[24:27], s63 offen sc1
    s_waitcnt lgkmcnt(0)
    s_barrier
    ds_read_b128 v[32:35], v126 offset:0
    ds_read_b128 v[36:39], v126 offset:1024
    ds_read_b32 v40, v127 offset:4096
    ds_read_b128 v[48:51], v126 offset:2048
    ds_read_b128 v[52:55], v126 offset:3072
    ds_read_b32 v56, v127 offset:4352
    s_waitcnt lgkmcnt(3)
    v_add_f32 v64, v64, v32
    v_add_f32 v65, v65, v33
    v_add_f32 v66, v66, v34
    v_add_f32 v67, v67, v35
    v_add_f32 v68, v68, v36
    v_add_f32 v69, v69, v37
    v_add_f32 v70, v70, v38
    v_add_f32 v71, v71, v39
    v_add_f32 v72, v72, v40
    s_waitcnt lgkmcnt(0)
    v_add_f32 v80, v80, v48
    v_add_f32 v81, v81, v49
    v_add_f32 v82, v82, v50
    v_add_f32 v83, v83, v51
    v_add_f32 v84, v84, v52
    v_add_f32 v85, v85, v53
    v_add_f32 v86, v86, v54
    v_add_f32 v87, v87, v55
    v_add_f32 v88, v88, v56
    v_rcp_f32 v120, v72
    s_nop 0
    v_mul_f32 v184, v64, v120
    v_mul_f32 v185, v65, v120
    v_mul_f32 v186, v66, v120
    v_mul_f32 v187, v67, v120
    v_mul_f32 v188, v68, v120
    v_mul_f32 v189, v69, v120
    v_mul_f32 v190, v70, v120
    v_mul_f32 v191, v71, v120
    v_cvt_pk_bf16_f32 v0, v184, v185
    v_cvt_pk_bf16_f32 v1, v186, v187
    v_cvt_pk_bf16_f32 v2, v188, v189
    v_cvt_pk_bf16_f32 v3, v190, v191
    buffer_store_dwordx4 v[0:3], v251, s[24:27], s55 offen sc1
    v_rcp_f32 v120, v88
    s_nop 0
    v_mul_f32 v184, v80, v120
    v_mul_f32 v185, v81, v120
    v_mul_f32 v186, v82, v120
    v_mul_f32 v187, v83, v120
    v_mul_f32 v188, v84, v120
    v_mul_f32 v189, v85, v120
    v_mul_f32 v190, v86, v120
    v_mul_f32 v191, v87, v120
    v_cvt_pk_bf16_f32 v4, v184, v185
    v_cvt_pk_bf16_f32 v5, v186, v187
    v_cvt_pk_bf16_f32 v6, v188, v189
    v_cvt_pk_bf16_f32 v7, v190, v191
    buffer_store_dwordx4 v[4:7], v251, s[24:27], s62 offen sc1
    v_add_f32 v120, |v64|, |v65|
    v_add_f32 v120, v120, |v66|
    v_add_f32 v120, v120, |v67|
    v_add_f32 v120, v120, |v68|
    v_add_f32 v120, v120, |v69|
    v_add_f32 v120, v120, |v70|
    v_add_f32 v120, v120, |v71|
    v_add_f32 v120, v120, |v72|
    v_add_f32 v120, v120, |v80|
    v_add_f32 v120, v120, |v81|
    v_add_f32 v120, v120, |v82|
    v_add_f32 v120, v120, |v83|
    v_add_f32 v120, v120, |v84|
    v_add_f32 v120, v120, |v85|
    v_add_f32 v120, v120, |v86|
    v_add_f32 v120, v120, |v87|
    v_add_f32 v120, v120, |v88|
    v_max3_f32 v121, |v64|, |v65|, |v66|
    v_max3_f32 v121, v121, |v67|, |v68|
    v_max3_f32 v121, v121, |v69|, |v70|
    v_max_f32 v121, v121, |v71|
    v_max3_f32 v122, |v80|, |v81|, |v82|
    v_max3_f32 v122, v122, |v83|, |v84|
    v_max3_f32 v122, v122, |v85|, |v86|
    v_max_f32 v122, v122, |v87|
    v_min3_f32 v121, v121, v122, v72
    v_min_f32 v121, v121, v88
    v_cmp_nlt_f32 s[64:65], v120, s60
    v_cmp_nge_f32 s[66:67], v121, s61
    s_nop 0
    s_or_b64 s[64:65], s[64:65], s[66:67]
    s_cbranch_scc1 M_slow
M_afin:
    v_mov_b32 v120, s35
    s_mov_b64 exec, 1
    buffer_store_dword v120, off, s[24:27], s52 sc1
    s_mov_b64 exec, -1
    s_lshl_b32 s64, s28, 13
    s_lshl_b32 s62, s33, 16
    s_add_u32 s62, s62, s64
    s_add_u32 s62, s62, 13631488
    s_mov_b32 s65, 3
    s_mov_b32 s66, 0
    s_mov_b32 s67, 200000
    s_lshl_b32 s61, s28, 3
    s_add_u32 s61, s61, 102912
    v_mov_b32 v121, s61
    s_mov_b32 s60, 0
    s_waitcnt vmcnt(3)
M_po:
    v_cmp_eq_u32 vcc, s35, v145
    s_bitcmp1_b32 s66, 0
    s_cbranch_scc0 M_pa0
    ds_write_b32 v121, v120 offset:0
M_pa0:
    s_bitcmp1_b32 s66, 1
    s_cbranch_scc0 M_pa1
    ds_write_b32 v121, v120 offset:4
M_pa1:
    s_mov_b32 s66, 0
    s_mov_b32 s60, 0
    s_cmp_eq_u32 s65, 0
    s_cbranch_scc1 M_pdone
    s_sub_u32 s67, s67, 1
    s_cselect_b32 vcc_lo, -1, vcc_lo
M_po2:
    s_bitcmp1_b32 s65, 0
    s_cbranch_scc0 M_pn0
    s_bfe_u32 s3, vcc_lo, 0x40000
    s_cmp_lg_u32 s3, 15
    s_cbranch_scc1 M_pn0
    s_call_b64 s[10:11], M_oi0
M_pn0:
    s_bitcmp1_b32 s65, 1
    s_cbranch_scc0 M_pn1
    s_bfe_u32 s3, vcc_lo, 0x40004
    s_cmp_lg_u32 s3, 15
    s_cbranch_scc1 M_pn1
    s_call_b64 s[10:11], M_oi1
M_pn1:
    s_cmp_lg_u32 s66, 3
    s_cbranch_scc1 M_pv
    s_lshl2_add_u32 s3, s60, s61
    v_mov_b32 v122, s3
    s_bitset0_b32 s66, s60
    s_waitcnt vmcnt(8)
    ds_write_b32 v122, v120
M_pv:
    s_cmp_eq_u32 s65, 0
    s_cbranch_scc1 M_pw
    buffer_load_dword v145, v144, s[24:27], s63 offen sc1
M_pw:
    s_waitcnt vmcnt(0)
    s_branch M_po
M_oi0:
    s_bitset0_b32 s65, 0
    s_bitset1_b32 s66, 0
    s_add_u32 m0, s64, 0
    s_add_u32 s3, s62, 0
    buffer_load_dwordx4 v251, s[24:27], s3 offen sc1 lds
    s_add_u32 m0, s64, 1024
    s_add_u32 s3, s62, 1024
    buffer_load_dwordx4 v251, s[24:27], s3 offen sc1 lds
    s_add_u32 m0, s64, 2048
    s_add_u32 s3, s62, 2048
    buffer_load_dwordx4 v251, s[24:27], s3 offen sc1 lds
    s_add_u32 m0, s64, 3072
    s_add_u32 s3, s62, 3072
    buffer_load_dwordx4 v251, s[24:27], s3 offen sc1 lds
    s_add_u32 m0, s64, 131072
    s_add_u32 s3, s62, 32768
    buffer_load_dwordx4 v251, s[24:27], s3 offen sc1 lds
    s_add_u32 m0, s64, 132096
    s_add_u32 s3, s62, 33792
    buffer_load_dwordx4 v251, s[24:27], s3 offen sc1 lds
    s_add_u32 m0, s64, 133120
    s_add_u32 s3, s62, 34816
    buffer_load_dwordx4 v251, s[24:27], s3 offen sc1 lds
    s_add_u32 m0, s64, 134144
    s_add_u32 s3, s62, 35840
    buffer_load_dwordx4 v251, s[24:27], s3 offen sc1 lds
    s_setpc_b64 s[10:11]
M_oi1:
    s_bitset0_b32 s65, 1
    s_bitset1_b32 s66, 1
    s_add_u32 m0, s64, 4096
    s_add_u32 s3, s62, 4096
    buffer_load_dwordx4 v251, s[24:27], s3 offen sc1 lds
    s_add_u32 m0, s64, 5120
    s_add_u32 s3, s62, 5120
    buffer_load_dwordx4 v251, s[24:27], s3 offen sc1 lds
    s_add_u32 m0, s64, 6144
    s_add_u32 s3, s62, 6144
    buffer_load_dwordx4 v251, s[24:27], s3 offen sc1 lds
    s_add_u32 m0, s64, 7168
    s_add_u32 s3, s62, 7168
    buffer_load_dwordx4 v251, s[24:27], s3 offen sc1 lds
    s_add_u32 m0, s64, 135168
    s_add_u32 s3, s62, 36864
    buffer_load_dwordx4 v251, s[24:27], s3 offen sc1 lds
    s_add_u32 m0, s64, 136192
    s_add_u32 s3, s62, 37888
    buffer_load_dwordx4 v251, s[24:27], s3 offen sc1 lds
    s_add_u32 m0, s64, 137216
    s_add_u32 s3, s62, 38912
    buffer_load_dwordx4 v251, s[24:27], s3 offen sc1 lds
    s_add_u32 m0, s64, 138240
    s_add_u32 s3, s62, 39936
    buffer_load_dwordx4 v251, s[24:27], s3 offen sc1 lds
    s_setpc_b64 s[10:11]
M_pdone:
    s_waitcnt lgkmcnt(0)
    s_endpgm
M_hf:
    s_cmp_eq_u32 s77, 0
    s_cbranch_scc1 M_hf0
    s_mul_i32 s3, s28, 5120
    s_add_u32 s3, s3, 0x18000
    v_add_u32 v124, s3, v251
    v_lshl_add_u32 v125, v255, 2, s3
    s_xor_b32 s3, s28, 1
    s_mul_i32 s3, s3, 5120
    s_add_u32 s3, s3, 0x18000
    v_add_u32 v126, s3, v251
    v_lshl_add_u32 v127, v255, 2, s3
    s_barrier
    s_branch M_hfr
M_hf0:
    s_lshl_b32 s3, s29, 4
    s_add_u32 s3, s3, s31
    s_lshl_b32 s3, s3, 2
    s_add_u32 s3, s3, s28
    s_mul_i32 s3, s3, 384
    s_add_u32 s3, s3, 16646144
    s_waitcnt vmcnt(0)
    v_mov_b32 v120, s35
    s_mov_b64 exec, 1
    buffer_store_dword v120, off, s[24:27], s3 sc1
    buffer_store_dword v120, off, s[24:27], s52 offset:128 sc1
    s_mov_b64 exec, -1
    v_lshlrev_b32 v253, 6, v255
    buffer_load_dword v254, v253, s[64:67], s68 offen
    s_branch M_hfr
M_slow:
    v_and_b32 v120, 15, v255
    v_lshlrev_b32 v120, 4, v120
    v_lshrrev_b32 v121, 5, v255
    v_lshl_add_u32 v252, v121, 8, v120
    v_add_u32 v252, 1024, v252
    s_waitcnt lgkmcnt(0)
    v_mov_b32 v120, 0xff800000
    v_mov_b32 v121, 0xff800000
    s_mov_b32 s3, s38
    s_mov_b32 s77, 0
M_sl1:
    buffer_load_dwordx4 v[112:115], v251, s[24:27], s3 offen sc1
    s_add_u32 s3, s3, 2048
    s_waitcnt vmcnt(0)
    v_mfma_f32_32x32x16_bf16 v[0:15], v[112:115], v[104:107], 0
    v_mfma_f32_32x32x16_bf16 v[16:31], v[112:115], v[108:111], 0
    s_nop 15
    s_nop 7
    v_max3_f32 v120, v120, v0, v1
    v_max3_f32 v120, v120, v2, v3
    v_max3_f32 v120, v120, v4, v5
    v_max3_f32 v120, v120, v6, v7
    v_max3_f32 v120, v120, v8, v9
    v_max3_f32 v120, v120, v10, v11
    v_max3_f32 v120, v120, v12, v13
    v_max3_f32 v120, v120, v14, v15
    v_max3_f32 v121, v121, v16, v17
    v_max3_f32 v121, v121, v18, v19
    v_max3_f32 v121, v121, v20, v21
    v_max3_f32 v121, v121, v22, v23
    v_max3_f32 v121, v121, v24, v25
    v_max3_f32 v121, v121, v26, v27
    v_max3_f32 v121, v121, v28, v29
    v_max3_f32 v121, v121, v30, v31
    s_add_u32 s77, s77, 1
    s_cmp_lg_u32 s77, 64
    s_cbranch_scc1 M_sl1
    v_mov_b32 v122, v120
    v_mov_b32 v123, v121
    s_nop 1
    v_permlane32_swap_b32 v120, v122
    v_permlane32_swap_b32 v121, v123
    s_nop 1
    v_max_f32 v120, v120, v122
    v_max_f32 v121, v121, v123
    v_sub_f32 v184, 0, v120
    v_sub_f32 v185, 0, v120
    v_sub_f32 v186, 0, v120
    v_sub_f32 v187, 0, v120
    v_sub_f32 v188, 0, v120
    v_sub_f32 v189, 0, v120
    v_sub_f32 v190, 0, v120
    v_sub_f32 v191, 0, v120
    v_sub_f32 v192, 0, v120
    v_sub_f32 v193, 0, v120
    v_sub_f32 v194, 0, v120
    v_sub_f32 v195, 0, v120
    v_sub_f32 v196, 0, v120
    v_sub_f32 v197, 0, v120
    v_sub_f32 v198, 0, v120
    v_sub_f32 v199, 0, v120
    v_sub_f32 v200, 0, v121
    v_sub_f32 v201, 0, v121
    v_sub_f32 v202, 0, v121
    v_sub_f32 v203, 0, v121
    v_sub_f32 v204, 0, v121
    v_sub_f32 v205, 0, v121
    v_sub_f32 v206, 0, v121
    v_sub_f32 v207, 0, v121
    v_sub_f32 v208, 0, v121
    v_sub_f32 v209, 0, v121
    v_sub_f32 v210, 0, v121
    v_sub_f32 v211, 0, v121
    v_sub_f32 v212, 0, v121
    v_sub_f32 v213, 0, v121
    v_sub_f32 v214, 0, v121
    v_sub_f32 v215, 0, v121
    v_mov_b32 v64, 0
    v_mov_b32 v65, 0
    v_mov_b32 v66, 0
    v_mov_b32 v67, 0
    v_mov_b32 v68, 0
    v_mov_b32 v69, 0
    v_mov_b32 v70, 0
    v_mov_b32 v71, 0
    v_mov_b32 v72, 0
    v_mov_b32 v73, 0
    v_mov_b32 v74, 0
    v_mov_b32 v75, 0
    v_mov_b32 v76, 0
    v_mov_b32 v77, 0
    v_mov_b32 v78, 0
    v_mov_b32 v79, 0
    v_mov_b32 v80, 0
    v_mov_b32 v81, 0
    v_mov_b32 v82, 0
    v_mov_b32 v83, 0
    v_mov_b32 v84, 0
    v_mov_b32 v85, 0
    v_mov_b32 v86, 0
    v_mov_b32 v87, 0
    v_mov_b32 v88, 0
    v_mov_b32 v89, 0
    v_mov_b32 v90, 0
    v_mov_b32 v91, 0
    v_mov_b32 v92, 0
    v_mov_b32 v93, 0
    v_mov_b32 v94, 0
    v_mov_b32 v95, 0
    s_mov_b32 s3, s38
    s_mov_b32 s77, 0
M_sl2:
    buffer_load_dwordx4 v[112:115], v251, s[24:27], s3 offen sc1
    s_mov_b64 exec, s[56:57]
    buffer_load_dwordx4 v[128:131], v252, s[24:27], s3 offen sc1
    buffer_load_dwordx4 v[132:135], v252, s[24:27], s3 offen offset:512 sc1
    s_mov_b64 exec, -1
    s_add_u32 s3, s3, 2048
    s_waitcnt vmcnt(0)
    v_mfma_f32_32x32x16_bf16 v[0:15], v[112:115], v[104:107], v[184:199]
    v_mfma_f32_32x32x16_bf16 v[16:31], v[112:115], v[108:111], v[200:215]
    s_nop 15
    s_nop 7
    v_exp_f32 v0, v0
    v_exp_f32 v1, v1
    v_exp_f32 v2, v2
    v_exp_f32 v3, v3
    v_exp_f32 v4, v4
    v_exp_f32 v5, v5
    v_exp_f32 v6, v6
    v_exp_f32 v7, v7
    v_exp_f32 v8, v8
    v_exp_f32 v9, v9
    v_exp_f32 v10, v10
    v_exp_f32 v11, v11
    v_exp_f32 v12, v12
    v_exp_f32 v13, v13
    v_exp_f32 v14, v14
    v_exp_f32 v15, v15
    v_exp_f32 v16, v16
    v_exp_f32 v17, v17
    v_exp_f32 v18, v18
    v_exp_f32 v19, v19
    v_exp_f32 v20, v20
    v_exp_f32 v21, v21
    v_exp_f32 v22, v22
    v_exp_f32 v23, v23
    v_exp_f32 v24, v24
    v_exp_f32 v25, v25
    v_exp_f32 v26, v26
    v_exp_f32 v27, v27
    v_exp_f32 v28, v28
    v_exp_f32 v29, v29
    v_exp_f32 v30, v30
    v_exp_f32 v31, v31
    s_nop 1
    v_smfmac_f32_32x32x32_bf16 v[64:79], v[128:131], v[0:7], v146
    v_smfmac_f32_32x32x32_bf16 v[64:79], v[132:135], v[8:15], v146
    v_smfmac_f32_32x32x32_bf16 v[80:95], v[128:131], v[16:23], v146
    v_smfmac_f32_32x32x32_bf16 v[80:95], v[132:135], v[24:31], v146
    s_nop 15
    s_add_u32 s77, s77, 1
    s_cmp_lg_u32 s77, 64
    s_cbranch_scc1 M_sl2
    s_nop 15
    s_nop 7
    v_rcp_f32 v120, v72
    s_nop 0
    v_mul_f32 v184, v64, v120
    v_mul_f32 v185, v65, v120
    v_mul_f32 v186, v66, v120
    v_mul_f32 v187, v67, v120
    v_mul_f32 v188, v68, v120
    v_mul_f32 v189, v69, v120
    v_mul_f32 v190, v70, v120
    v_mul_f32 v191, v71, v120
    v_cvt_pk_bf16_f32 v0, v184, v185
    v_cvt_pk_bf16_f32 v1, v186, v187
    v_cvt_pk_bf16_f32 v2, v188, v189
    v_cvt_pk_bf16_f32 v3, v190, v191
    buffer_store_dwordx4 v[0:3], v251, s[24:27], s55 offen sc1
    v_rcp_f32 v120, v88
    s_nop 0
    v_mul_f32 v184, v80, v120
    v_mul_f32 v185, v81, v120
    v_mul_f32 v186, v82, v120
    v_mul_f32 v187, v83, v120
    v_mul_f32 v188, v84, v120
    v_mul_f32 v189, v85, v120
    v_mul_f32 v190, v86, v120
    v_mul_f32 v191, v87, v120
    v_cvt_pk_bf16_f32 v4, v184, v185
    v_cvt_pk_bf16_f32 v5, v186, v187
    v_cvt_pk_bf16_f32 v6, v188, v189
    v_cvt_pk_bf16_f32 v7, v190, v191
    buffer_store_dwordx4 v[4:7], v251, s[24:27], s62 offen sc1
    s_waitcnt vmcnt(0)
    s_branch M_afin
M_end:
    s_endpgm
M_codeend:

.section .rodata,"a"
.p2align 6
.amdhsa_kernel recurrent_scan__mha_block__glu_gated_reglu__prompt_kernel
  .amdhsa_next_free_vgpr 256
  .amdhsa_next_free_sgpr 102
  .amdhsa_accum_offset 256
  .amdhsa_group_segment_fixed_size 0
  .amdhsa_kernarg_size 80
  .amdhsa_user_sgpr_count 2
  .amdhsa_user_sgpr_kernarg_segment_ptr 1
  .amdhsa_system_sgpr_workgroup_id_x 1
  .amdhsa_float_denorm_mode_32 3
  .amdhsa_float_denorm_mode_16_64 3
.end_amdhsa_kernel
```
